```python
import torch

def _softmax(x, axis=-1):
    return torch.softmax(x, dim=axis)
def _gelu(x):
    return torch.nn.functional.gelu(x, approximate="tanh")
def _silu(x):
    return torch.nn.functional.silu(x)
def _sigmoid(x):
    return torch.sigmoid(x)
def _layernorm(x, axis=-1, eps=1e-5):
    m = x.mean(dim=axis, keepdim=True)
    v = x.var(dim=axis, keepdim=True, unbiased=False)
    return (x - m) / torch.sqrt(v + eps)
def _scatter_add(tgt, idx, src, axis=0):
    return tgt.clone().index_add_(axis, idx, src)
def _segment_sum(src, seg, n):
    out = torch.zeros((n,) + src.shape[1:], dtype=src.dtype)
    return out.index_add_(0, seg, src)
def _pad(x, pw):
    flat = tuple(v for pair in reversed(pw) for v in pair)
    return torch.nn.functional.pad(x, flat)

kernel_name = 'gated_mix__grouped_kv_mqa__sliding_block__prompt'

def setup_inputs():

    _w = (lambda a: (lambda t: t.to(torch.bfloat16) if t.is_floating_point() else t)(torch.as_tensor(a)))
    def _A_setup():
        B, S, D, H = 1, 2048, 1024, 32
        Dh = D // H
        return {
            "x": _w((lambda *s: torch.randn(*s, dtype=torch.bfloat16) * 0.05)(B, S, D)),
            "wq": _w((lambda *s: torch.randn(*s, dtype=torch.bfloat16) * 0.8)(D, H * Dh)),
            "wk": _w((lambda *s: torch.randn(*s, dtype=torch.bfloat16) * 0.8)(D, Dh)),
            "wv": _w((lambda *s: torch.randn(*s, dtype=torch.bfloat16) * 0.2)(D, Dh)),
            "wo": _w((lambda *s: torch.randn(*s, dtype=torch.bfloat16) * 0.2)(H * Dh, D)),
        }
    _A_in = _A_setup()

    def _B_setup():
        B, S, D = 1, 2048, 1024
        return {
            "x": _w((lambda *s: torch.randn(*s, dtype=torch.bfloat16) * 0.05)(B, S, D)),
            "wqkv": _w((lambda *s: torch.randn(*s, dtype=torch.bfloat16) * 0.8)(D, 3 * D)),
            "wo": _w((lambda *s: torch.randn(*s, dtype=torch.bfloat16) * 0.05)(D, D)),
        }
    _B_in = _B_setup()

    return {
        "A_x": _A_in["x"],
        "A_wq": _A_in["wq"],
        "A_wk": _A_in["wk"],
        "A_wv": _A_in["wv"],
        "A_wo": _A_in["wo"],
        "B_x": _B_in["x"],
        "B_wqkv": _B_in["wqkv"],
        "B_wo": _B_in["wo"],
        "gate_w": _w((lambda *s: torch.randn(*s, dtype=torch.bfloat16) * 0.05)(1024) * 16.0),
    }

def reference(A_x, A_wq, A_wk, A_wv, A_wo, B_x, B_wqkv, B_wo, gate_w):
    def _A_ref(x, wq, wk, wv, wo):
        B, S, D = x.shape
        H = 32
        Dh = D // H
        q = (lambda x, *d: x.permute(*d))((x @ wq).reshape(B, S, H, Dh), 0, 2, 1, 3)
        k = x @ wk
        v = x @ wv
        scores = torch.einsum("bhqd,bkd->bhqk", q, k) * (Dh ** -0.5)
        p = _softmax(scores, axis=-1)
        o = torch.einsum("bhqk,bkd->bhqd", p, v)
        return (lambda x, *d: x.permute(*d))(o, 0, 2, 1, 3).reshape(B, S, H * Dh) @ wo

    def _B_ref(x, wqkv, wo):
        B, S, D = x.shape
        H = 32; Dh = D // H; W = 256
        qkv = (lambda x, *d: x.permute(*d))((x @ wqkv).reshape(B, S, 3, H, Dh), 2, 0, 3, 1, 4)
        q, k, v = qkv[0], qkv[1], qkv[2]
        scores = torch.einsum("bhqd,bhkd->bhqk", q, k) * (Dh ** -0.5)
        idx = torch.arange(S)
        mask = (idx[:, None] - idx[None, :] >= 0) & (idx[:, None] - idx[None, :] < W)
        scores = torch.where(mask[None, None], scores, -1e9)
        p = _softmax(scores, axis=-1)
        o = torch.einsum("bhqk,bhkd->bhqd", p, v)
        return (lambda x, *d: x.permute(*d))(o, 0, 2, 1, 3).reshape(B, S, D) @ wo

    x = A_x
    g = _sigmoid((x * gate_w).sum(-1, keepdims=True))
    a = _A_ref(x, A_wq, A_wk, A_wv, A_wo)
    b = _B_ref(x, B_wqkv, B_wo)
    return g * a + (1 - g) * b
```

```asm
; @launch grid=(256,1,1) block=(512,1,1) lds=163840
.amdgcn_target "amdgcn-amd-amdhsa--gfx950"
.text
.globl gated_mix__grouped_kv_mqa__sliding_block__prompt_kernel
.p2align 8
.type gated_mix__grouped_kv_mqa__sliding_block__prompt_kernel,@function
gated_mix__grouped_kv_mqa__sliding_block__prompt_kernel:
    s_cmp_ge_u32 s2, 256
    s_cbranch_scc1 f_end2
    s_load_dwordx8 s[4:11], s[0:1], 0
    s_load_dwordx8 s[16:23], s[0:1], 48
    s_load_dwordx4 s[24:27], s[0:1], 80
    s_load_dwordx2 s[12:13], s[0:1], 32
    v_lshrrev_b32 v1, 6, v0
    v_and_b32 v0, 63, v0
    v_readfirstlane_b32 s3, v1
    s_and_b32 s50, s2, 7
    s_lshr_b32 s51, s2, 3
    s_and_b32 s48, s50, 1
    s_lshl_b32 s48, s48, 3
    s_and_b32 s56, s51, 7
    s_add_u32 s48, s48, s56
    s_lshr_b32 s49, s50, 1
    s_lshl_b32 s49, s49, 2
    s_lshr_b32 s56, s51, 3
    s_add_u32 s49, s49, s56
    v_lshlrev_b32 v1, 4, v0
    s_cmp_lt_u32 s3, 4
    s_cbranch_scc1 f_compute
    s_setprio 3
    s_sub_u32 s14, s3, 4
    v_lshrrev_b32 v9, 3, v0
    v_and_b32 v16, 7, v0
    v_lshrrev_b32 v17, 4, v0
    v_xor_b32 v17, v17, v16
    v_lshlrev_b32 v17, 4, v17
    v_lshl_add_u32 v128, v9, 11, v17
    v_xor_b32 v129, 64, v128
    s_cmp_eq_u32 s14, 0
    s_mov_b32 s57, 6144
    s_cselect_b32 s57, 2048, s57
    v_bfe_u32 v17, v0, 4, 1
    v_lshlrev_b32 v17, 1, v17
    v_xor_b32 v17, v17, v16
    v_lshlrev_b32 v17, 4, v17
    v_mul_u32_u24 v18, s57, v9
    v_add_u32 v130, v18, v17
    v_xor_b32 v131, 64, v130
    s_lshl_b32 s96, s57, 3
    s_lshl_b32 s93, s48, 18
    s_lshl_b32 s56, s14, 16
    s_add_u32 s93, s93, s56
    s_max_u32 s56, s14, 1
    s_sub_u32 s56, s56, 1
    s_lshl_b32 s56, s56, 11
    s_mul_i32 s57, s14, 1
    s_add_u32 s57, s57, s49
    s_and_b32 s57, s57, 3
    s_and_b32 s94, s49, 12
    s_or_b32 s57, s57, s94
    s_lshl_b32 s57, s57, 7
    s_add_u32 s94, s56, s57
    s_add_u32 s92, s48, s49
    s_and_b32 s92, s92, 3
    s_and_b32 s56, s49, 12
    s_or_b32 s98, s92, s56
    s_lshl_b32 s98, s98, 0
    s_lshl_b32 s99, s14, 12
    s_lshl_b32 s100, s14, 13
    s_add_u32 s2, s100, 16384
    s_sub_u32 s53, s96, 0x400
    s_cmp_eq_u32 s14, 0
    s_waitcnt lgkmcnt(0)
    s_cselect_b32 s40, s6, s16
    s_cselect_b32 s41, s7, s17
    s_mov_b32 s42, 6291456
    s_cselect_b32 s42, 2097152, s42
    s_mov_b32 s43, 0x20000
    s_mov_b32 s36, s4
    s_mov_b32 s37, s5
    s_mov_b32 s38, 4194304
    s_mov_b32 s39, 0x20000
    s_and_b32 s98, s98, 13
    s_mov_b32 s95, s98
    s_mov_b32 s59, 0
    s_getpc_b64 s[0:1]
f_ipc:
    s_add_u32 s0, s0, f_iret-f_ipc
    s_addc_u32 s1, s1, 0
f_isub:
    s_add_u32 m0, s99, s59
    s_lshl_b32 s56, s98, 7
    s_add_u32 s56, s56, s93
    buffer_load_dwordx4 v128, s[36:39], s56 offen offset:0  lds
    s_addk_i32 s56, 15360
    buffer_load_dwordx4 v129, s[36:39], s56 offen offset:1024  lds
    s_addk_i32 s56, 15360
    buffer_load_dwordx4 v128, s[36:39], s56 offen offset:2048  lds
    s_addk_i32 s56, 15360
    buffer_load_dwordx4 v129, s[36:39], s56 offen offset:3072  lds
    s_add_u32 m0, s2, s59
    s_mul_i32 s56, s98, s96
    s_lshl_b32 s56, s56, 3
    s_add_u32 s56, s56, s94
    buffer_load_dwordx4 v130, s[40:43], s56 offen offset:0  lds
    s_add_u32 s56, s56, s53
    buffer_load_dwordx4 v131, s[40:43], s56 offen offset:1024  lds
    s_add_u32 s56, s56, s53
    buffer_load_dwordx4 v130, s[40:43], s56 offen offset:2048  lds
    s_add_u32 s56, s56, s53
    buffer_load_dwordx4 v131, s[40:43], s56 offen offset:3072  lds
    s_addk_i32 m0, 0x1000
    s_addk_i32 s56, 0x1000
    s_add_u32 s56, s56, s53
    buffer_load_dwordx4 v130, s[40:43], s56 offen offset:0  lds
    s_add_u32 s56, s56, s53
    buffer_load_dwordx4 v131, s[40:43], s56 offen offset:1024  lds
    s_add_u32 s56, s56, s53
    buffer_load_dwordx4 v130, s[40:43], s56 offen offset:2048  lds
    s_add_u32 s56, s56, s53
    buffer_load_dwordx4 v131, s[40:43], s56 offen offset:3072  lds
    s_add_u32 s56, s98, 1
    s_and_b32 s56, s56, 3
    s_and_b32 s98, s98, 12
    s_or_b32 s98, s98, s56
    s_setpc_b64 s[0:1]
f_iret:
    s_and_b32 s15, s92, 1
    s_cmp_eq_u32 s15, 0
    s_cselect_b32 s44, s8, s10
    s_cselect_b32 s45, s9, s11
    s_mov_b32 s46, 65536
    s_mov_b32 s47, 0x20000
    s_and_b32 s58, s92, 2
    s_xor_b32 s58, s58, s95
    s_xor_b32 s60, s58, 1
    s_cmp_lt_u32 s14, 2
    s_cselect_b32 s56, s58, s60
    s_lshl_b32 s56, s56, 12
    s_and_b32 s57, s14, 1
    s_lshl_b32 s57, s57, 11
    s_add_u32 s56, s56, s57
    s_lshl_b32 s57, s14, 11
    s_add_u32 m0, s57, 147456
    v_mov_b32 v17, s58
    buffer_load_dwordx4 v1, s[44:47], s56 offen lds
    buffer_load_dwordx4 v1, s[44:47], s56 offen offset:1024 lds
    v_mov_b32 v18, s60
    v_cmp_gt_u32 vcc, 8, v0
    v_lshlrev_b32 v19, 4, v16
    v_lshrrev_b32 v20, 4, v0
    v_cndmask_b32 v17, v18, v17, vcc
    v_lshl_add_u32 v19, v17, 7, v19
    v_lshl_add_u32 v19, v20, 16, v19
    s_lshl_b32 s57, s14, 10
    s_add_u32 s57, s57, 155648
    s_mov_b32 m0, s57
    s_mov_b32 s60, s20
    s_mov_b32 s61, s21
    s_mov_b32 s62, 2048
    s_mov_b32 s63, 0x20000
    buffer_load_dwordx4 v19, s[60:63], 0 offen lds
    v_lshrrev_b32 v17, 5, v0
    v_lshl_add_u32 v134, v17, 4, s57
    s_mov_b32 s28, s26
    s_mov_b32 s29, s27
    s_mov_b32 s30, 26214400
    s_mov_b32 s31, 0x20000
    s_mov_b32 s32, s24
    s_mov_b32 s33, s25
    s_mov_b32 s34, 256
    s_mov_b32 s35, 0x20000
    v_and_b32 v16, 31, v0
    v_lshrrev_b32 v17, 5, v0
    v_bfe_u32 v18, v0, 1, 3
    v_xor_b32 v19, v17, v18
    v_lshlrev_b32 v19, 4, v19
    v_lshl_add_u32 v19, v16, 7, v19
    v_add_u32 v136, s99, v19
    v_xor_b32 v137, 32, v136
    v_xor_b32 v138, 64, v136
    v_xor_b32 v139, 0x60, v136
    v_bfe_u32 v18, v0, 2, 2
    v_lshl_add_u32 v19, v17, 3, v18
    v_lshlrev_b32 v19, 6, v19
    v_bfe_u32 v18, v0, 4, 1
    v_lshl_add_u32 v19, v18, 5, v19
    v_and_b32 v18, 3, v0
    v_bfe_u32 v20, v0, 1, 1
    v_and_b32 v21, 1, v0
    v_lshl_or_b32 v20, v21, 1, v20
    s_cmp_eq_u32 s15, 0
    s_cselect_b64 vcc, -1, 0
    v_cndmask_b32 v18, v18, v20, vcc
    v_lshl_add_u32 v19, v18, 3, v19
    v_add_u32 v133, 147456, v19
    v_lshlrev_b32 v132, 2, v0
    v_mov_b32 v64, 0
    v_mov_b32 v65, 0
    s_lshr_b32 s97, s58, 1
    s_lshl_b32 s101, s48, 1
    s_add_u32 s101, s101, s15
    s_lshl_b32 s101, s101, 17
    s_add_u32 s101, s101, 0
    s_xor_b32 s98, s95, 1
    s_mov_b32 s59, 98304
    s_call_b64 s[0:1], f_isub
    s_waitcnt vmcnt(12)
    s_barrier
    s_bitcmp1_b32 s92, 1
    s_cbranch_scc1 f_lx0
    ds_read_b128 v[144:147], v136
    ds_read_b128 v[148:151], v137
    ds_read_b128 v[152:155], v138
    ds_read_b128 v[156:159], v139
    ds_read_b64_tr_b16 v[176:177], v133 offset:0
    ds_read_b64_tr_b16 v[178:179], v133 offset:256
    ds_read_b64_tr_b16 v[180:181], v133 offset:1024
    ds_read_b64_tr_b16 v[182:183], v133 offset:1280
    ds_read_b64_tr_b16 v[184:185], v133 offset:2048
    ds_read_b64_tr_b16 v[186:187], v133 offset:2304
    ds_read_b64_tr_b16 v[188:189], v133 offset:3072
    ds_read_b64_tr_b16 v[190:191], v133 offset:3328
f_lx0:
    v_add_u32 v136, 98304, v136
    v_add_u32 v137, 98304, v137
    v_add_u32 v138, 98304, v138
    v_add_u32 v139, 98304, v139
    s_xor_b32 s98, s95, 2
    s_mov_b32 s59, 49152
    s_call_b64 s[0:1], f_isub
    s_bitcmp1_b32 s92, 1
    s_cbranch_scc1 f_lw0
    s_waitcnt lgkmcnt(4)
    s_cmp_eq_u32 s15, 1
    s_cbranch_scc1 f_lv0
    ds_read_b128 v[32:35], v134 offset:0
    ds_read_b128 v[36:39], v134 offset:32
    ds_read_b128 v[40:43], v134 offset:64
    ds_read_b128 v[44:47], v134 offset:96
    s_waitcnt lgkmcnt(4)
    v_mfma_f32_32x32x16_bf16 v[208:223], v[176:179], v[144:147], 0
    v_mfma_f32_32x32x16_bf16 v[208:223], v[180:183], v[148:151], v[208:223]
    v_mfma_f32_32x32x16_bf16 v[208:223], v[184:187], v[152:155], v[208:223]
    v_mfma_f32_32x32x16_bf16 v[208:223], v[188:191], v[156:159], v[208:223]
    s_waitcnt lgkmcnt(0)
    v_dot2_f32_bf16 v64, v144, v32, v64
    v_dot2_f32_bf16 v65, v145, v33, v65
    v_dot2_f32_bf16 v64, v146, v34, v64
    v_dot2_f32_bf16 v65, v147, v35, v65
    v_dot2_f32_bf16 v64, v148, v36, v64
    v_dot2_f32_bf16 v65, v149, v37, v65
    v_dot2_f32_bf16 v64, v150, v38, v64
    v_dot2_f32_bf16 v65, v151, v39, v65
    v_dot2_f32_bf16 v64, v152, v40, v64
    v_dot2_f32_bf16 v65, v153, v41, v65
    v_dot2_f32_bf16 v64, v154, v42, v64
    v_dot2_f32_bf16 v65, v155, v43, v65
    v_dot2_f32_bf16 v64, v156, v44, v64
    v_dot2_f32_bf16 v65, v157, v45, v65
    v_dot2_f32_bf16 v64, v158, v46, v64
    v_dot2_f32_bf16 v65, v159, v47, v65
    s_branch f_lw0
f_lv0:
    s_waitcnt lgkmcnt(0)
    v_mfma_f32_32x32x16_bf16 v[208:223], v[144:147], v[176:179], 0
    v_mfma_f32_32x32x16_bf16 v[208:223], v[148:151], v[180:183], v[208:223]
    v_mfma_f32_32x32x16_bf16 v[208:223], v[152:155], v[184:187], v[208:223]
    v_mfma_f32_32x32x16_bf16 v[208:223], v[156:159], v[188:191], v[208:223]
f_lw0:
    s_waitcnt vmcnt(12)
    s_barrier
    s_bitcmp1_b32 s92, 1
    s_cbranch_scc1 f_lx1
    ds_read_b128 v[160:163], v136
    ds_read_b128 v[164:167], v137
    ds_read_b128 v[168:171], v138
    ds_read_b128 v[172:175], v139
    ds_read_b64_tr_b16 v[192:193], v133 offset:4096
    ds_read_b64_tr_b16 v[194:195], v133 offset:4352
    ds_read_b64_tr_b16 v[196:197], v133 offset:5120
    ds_read_b64_tr_b16 v[198:199], v133 offset:5376
    ds_read_b64_tr_b16 v[200:201], v133 offset:6144
    ds_read_b64_tr_b16 v[202:203], v133 offset:6400
    ds_read_b64_tr_b16 v[204:205], v133 offset:7168
    ds_read_b64_tr_b16 v[206:207], v133 offset:7424
f_lx1:
    v_add_u32 v136, 4294918144, v136
    v_add_u32 v137, 4294918144, v137
    v_add_u32 v138, 4294918144, v138
    v_add_u32 v139, 4294918144, v139
    s_xor_b32 s98, s95, 3
    s_mov_b32 s59, 0
    s_call_b64 s[0:1], f_isub
    s_bitcmp1_b32 s92, 1
    s_cbranch_scc1 f_lw1
    s_waitcnt lgkmcnt(4)
    s_cmp_eq_u32 s15, 1
    s_cbranch_scc1 f_lv1
    ds_read_b128 v[48:51], v134 offset:128
    ds_read_b128 v[52:55], v134 offset:160
    ds_read_b128 v[56:59], v134 offset:192
    ds_read_b128 v[60:63], v134 offset:224
    s_waitcnt lgkmcnt(4)
    v_mfma_f32_32x32x16_bf16 v[208:223], v[192:195], v[160:163], v[208:223]
    v_mfma_f32_32x32x16_bf16 v[208:223], v[196:199], v[164:167], v[208:223]
    v_mfma_f32_32x32x16_bf16 v[208:223], v[200:203], v[168:171], v[208:223]
    v_mfma_f32_32x32x16_bf16 v[208:223], v[204:207], v[172:175], v[208:223]
    s_waitcnt lgkmcnt(0)
    v_dot2_f32_bf16 v64, v160, v48, v64
    v_dot2_f32_bf16 v65, v161, v49, v65
    v_dot2_f32_bf16 v64, v162, v50, v64
    v_dot2_f32_bf16 v65, v163, v51, v65
    v_dot2_f32_bf16 v64, v164, v52, v64
    v_dot2_f32_bf16 v65, v165, v53, v65
    v_dot2_f32_bf16 v64, v166, v54, v64
    v_dot2_f32_bf16 v65, v167, v55, v65
    v_dot2_f32_bf16 v64, v168, v56, v64
    v_dot2_f32_bf16 v65, v169, v57, v65
    v_dot2_f32_bf16 v64, v170, v58, v64
    v_dot2_f32_bf16 v65, v171, v59, v65
    v_dot2_f32_bf16 v64, v172, v60, v64
    v_dot2_f32_bf16 v65, v173, v61, v65
    v_dot2_f32_bf16 v64, v174, v62, v64
    v_dot2_f32_bf16 v65, v175, v63, v65
    s_branch f_lw1
f_lv1:
    s_waitcnt lgkmcnt(0)
    v_mfma_f32_32x32x16_bf16 v[208:223], v[160:163], v[192:195], v[208:223]
    v_mfma_f32_32x32x16_bf16 v[208:223], v[164:167], v[196:199], v[208:223]
    v_mfma_f32_32x32x16_bf16 v[208:223], v[168:171], v[200:203], v[208:223]
    v_mfma_f32_32x32x16_bf16 v[208:223], v[172:175], v[204:207], v[208:223]
f_lw1:
    s_waitcnt vmcnt(12)
    s_barrier
    s_bitcmp0_b32 s92, 1
    s_cbranch_scc1 f_lx2
    ds_read_b128 v[144:147], v136
    ds_read_b128 v[148:151], v137
    ds_read_b128 v[152:155], v138
    ds_read_b128 v[156:159], v139
    ds_read_b64_tr_b16 v[176:177], v133 offset:0
    ds_read_b64_tr_b16 v[178:179], v133 offset:256
    ds_read_b64_tr_b16 v[180:181], v133 offset:1024
    ds_read_b64_tr_b16 v[182:183], v133 offset:1280
    ds_read_b64_tr_b16 v[184:185], v133 offset:2048
    ds_read_b64_tr_b16 v[186:187], v133 offset:2304
    ds_read_b64_tr_b16 v[188:189], v133 offset:3072
    ds_read_b64_tr_b16 v[190:191], v133 offset:3328
f_lx2:
    v_add_u32 v136, 4294918144, v136
    v_add_u32 v137, 4294918144, v137
    v_add_u32 v138, 4294918144, v138
    v_add_u32 v139, 4294918144, v139
    s_and_b32 s98, s98, 12
    s_or_b32 s98, s98, s92
    s_add_u32 s98, s98, 4
    s_and_b32 s98, s98, 15
    s_mov_b32 s59, 98304
    s_call_b64 s[0:1], f_isub
    s_bitcmp0_b32 s92, 1
    s_cbranch_scc1 f_lw2
    s_waitcnt lgkmcnt(4)
    s_cmp_eq_u32 s15, 1
    s_cbranch_scc1 f_lv2
    ds_read_b128 v[32:35], v134 offset:0
    ds_read_b128 v[36:39], v134 offset:32
    ds_read_b128 v[40:43], v134 offset:64
    ds_read_b128 v[44:47], v134 offset:96
    s_waitcnt lgkmcnt(4)
    v_mfma_f32_32x32x16_bf16 v[208:223], v[176:179], v[144:147], 0
    v_mfma_f32_32x32x16_bf16 v[208:223], v[180:183], v[148:151], v[208:223]
    v_mfma_f32_32x32x16_bf16 v[208:223], v[184:187], v[152:155], v[208:223]
    v_mfma_f32_32x32x16_bf16 v[208:223], v[188:191], v[156:159], v[208:223]
    s_waitcnt lgkmcnt(0)
    v_dot2_f32_bf16 v64, v144, v32, v64
    v_dot2_f32_bf16 v65, v145, v33, v65
    v_dot2_f32_bf16 v64, v146, v34, v64
    v_dot2_f32_bf16 v65, v147, v35, v65
    v_dot2_f32_bf16 v64, v148, v36, v64
    v_dot2_f32_bf16 v65, v149, v37, v65
    v_dot2_f32_bf16 v64, v150, v38, v64
    v_dot2_f32_bf16 v65, v151, v39, v65
    v_dot2_f32_bf16 v64, v152, v40, v64
    v_dot2_f32_bf16 v65, v153, v41, v65
    v_dot2_f32_bf16 v64, v154, v42, v64
    v_dot2_f32_bf16 v65, v155, v43, v65
    v_dot2_f32_bf16 v64, v156, v44, v64
    v_dot2_f32_bf16 v65, v157, v45, v65
    v_dot2_f32_bf16 v64, v158, v46, v64
    v_dot2_f32_bf16 v65, v159, v47, v65
    s_branch f_lw2
f_lv2:
    s_waitcnt lgkmcnt(0)
    v_mfma_f32_32x32x16_bf16 v[208:223], v[144:147], v[176:179], 0
    v_mfma_f32_32x32x16_bf16 v[208:223], v[148:151], v[180:183], v[208:223]
    v_mfma_f32_32x32x16_bf16 v[208:223], v[152:155], v[184:187], v[208:223]
    v_mfma_f32_32x32x16_bf16 v[208:223], v[156:159], v[188:191], v[208:223]
f_lw2:
    s_waitcnt vmcnt(12)
    s_barrier
    s_bitcmp0_b32 s92, 1
    s_cbranch_scc1 f_lx3
    ds_read_b128 v[160:163], v136
    ds_read_b128 v[164:167], v137
    ds_read_b128 v[168:171], v138
    ds_read_b128 v[172:175], v139
    ds_read_b64_tr_b16 v[192:193], v133 offset:4096
    ds_read_b64_tr_b16 v[194:195], v133 offset:4352
    ds_read_b64_tr_b16 v[196:197], v133 offset:5120
    ds_read_b64_tr_b16 v[198:199], v133 offset:5376
    ds_read_b64_tr_b16 v[200:201], v133 offset:6144
    ds_read_b64_tr_b16 v[202:203], v133 offset:6400
    ds_read_b64_tr_b16 v[204:205], v133 offset:7168
    ds_read_b64_tr_b16 v[206:207], v133 offset:7424
f_lx3:
    s_mov_b32 s59, 49152
    s_call_b64 s[0:1], f_isub
    s_bitcmp0_b32 s92, 1
    s_cbranch_scc1 f_lw3
    s_waitcnt lgkmcnt(4)
    s_cmp_eq_u32 s15, 1
    s_cbranch_scc1 f_lv3
    ds_read_b128 v[48:51], v134 offset:128
    ds_read_b128 v[52:55], v134 offset:160
    ds_read_b128 v[56:59], v134 offset:192
    ds_read_b128 v[60:63], v134 offset:224
    s_waitcnt lgkmcnt(4)
    v_mfma_f32_32x32x16_bf16 v[208:223], v[192:195], v[160:163], v[208:223]
    v_mfma_f32_32x32x16_bf16 v[208:223], v[196:199], v[164:167], v[208:223]
    v_mfma_f32_32x32x16_bf16 v[208:223], v[200:203], v[168:171], v[208:223]
    v_mfma_f32_32x32x16_bf16 v[208:223], v[204:207], v[172:175], v[208:223]
    s_waitcnt lgkmcnt(0)
    v_dot2_f32_bf16 v64, v160, v48, v64
    v_dot2_f32_bf16 v65, v161, v49, v65
    v_dot2_f32_bf16 v64, v162, v50, v64
    v_dot2_f32_bf16 v65, v163, v51, v65
    v_dot2_f32_bf16 v64, v164, v52, v64
    v_dot2_f32_bf16 v65, v165, v53, v65
    v_dot2_f32_bf16 v64, v166, v54, v64
    v_dot2_f32_bf16 v65, v167, v55, v65
    v_dot2_f32_bf16 v64, v168, v56, v64
    v_dot2_f32_bf16 v65, v169, v57, v65
    v_dot2_f32_bf16 v64, v170, v58, v64
    v_dot2_f32_bf16 v65, v171, v59, v65
    v_dot2_f32_bf16 v64, v172, v60, v64
    v_dot2_f32_bf16 v65, v173, v61, v65
    v_dot2_f32_bf16 v64, v174, v62, v64
    v_dot2_f32_bf16 v65, v175, v63, v65
    s_branch f_lw3
f_lv3:
    s_waitcnt lgkmcnt(0)
    v_mfma_f32_32x32x16_bf16 v[208:223], v[160:163], v[192:195], v[208:223]
    v_mfma_f32_32x32x16_bf16 v[208:223], v[164:167], v[196:199], v[208:223]
    v_mfma_f32_32x32x16_bf16 v[208:223], v[168:171], v[200:203], v[208:223]
    v_mfma_f32_32x32x16_bf16 v[208:223], v[172:175], v[204:207], v[208:223]
f_lw3:
    s_nop 7
    s_lshl_b32 s56, s14, 3
    s_add_u32 s56, s56, s97
    s_lshl_b32 s57, s56, 12
    s_add_u32 s57, s57, s101
    v_add_f32 v64, v64, v65
    v_cvt_pk_bf16_f32 v224, v208, v209
    v_cvt_pk_bf16_f32 v225, v210, v211
    v_cvt_pk_bf16_f32 v226, v212, v213
    v_cvt_pk_bf16_f32 v227, v214, v215
    v_cvt_pk_bf16_f32 v228, v216, v217
    v_cvt_pk_bf16_f32 v229, v218, v219
    v_cvt_pk_bf16_f32 v230, v220, v221
    v_cvt_pk_bf16_f32 v231, v222, v223
    buffer_store_dwordx4 v[224:227], v1, s[28:31], s57 offen offset:0 sc1
    buffer_store_dwordx4 v[228:231], v1, s[28:31], s57 offen offset:2048 sc1
    s_cmp_eq_u32 s15, 1
    s_cbranch_scc1 f_lp1
    s_lshl_b32 s57, s48, 5
    s_add_u32 s56, s56, s57
    s_lshl_b32 s56, s56, 8
    s_add_u32 s56, s56, 5242880
    buffer_store_dword v64, v132, s[28:31], s56 offen sc1
f_lp1:
    s_waitcnt vmcnt(14)
    s_barrier
    v_mov_b32 v17, 0
    buffer_load_dword v18, v17, s[32:35], 0 offen sc1
    s_mov_b32 s59, 0
    s_call_b64 s[0:1], f_isub
    s_waitcnt vmcnt(12)
    s_mov_b32 s57, 50000
f_tll:
    v_readfirstlane_b32 s64, v18
    s_cmp_lg_u32 s64, 0
    s_cbranch_scc1 f_tdl
    s_sleep 8
    buffer_load_dword v18, v17, s[32:35], 0 offen sc1
    s_waitcnt vmcnt(0)
    s_sub_u32 s57, s57, 1
    s_cmp_lg_u32 s57, 0
    s_cbranch_scc1 f_tll
f_tdl:
    s_barrier
    s_cmp_lg_u32 s14, 0
    s_cbranch_scc1 f_ls5
    s_mov_b64 exec, 1
    v_mov_b32 v7, s64
    v_mov_b32 v17, 0
    s_lshl_b32 s56, s48, 4
    s_add_u32 s56, s56, s49
    s_lshl_b32 s56, s56, 4
    s_add_u32 s56, s56, 4194304
    buffer_store_dword v7, v17, s[28:31], s56 offen sc1
    s_mov_b64 exec, -1
f_ls5:
    s_mov_b32 s59, 98304
    s_call_b64 s[0:1], f_isub
    s_waitcnt vmcnt(12)
    s_barrier
    s_add_u32 s98, s98, 4
    s_and_b32 s98, s98, 15
    s_mov_b32 s59, 49152
    s_call_b64 s[0:1], f_isub
    s_waitcnt vmcnt(12)
    s_barrier
    s_mov_b32 s59, 0
    s_call_b64 s[0:1], f_isub
    s_waitcnt vmcnt(12)
    s_barrier
    s_and_b32 s58, s97, 1
    s_add_u32 s58, s58, s15
    s_add_u32 s58, s58, s14
    s_cmp_eq_u32 s14, 0
    s_cselect_b32 s58, 0, s58
    v_and_b32 v16, 7, v0
    v_lshlrev_b32 v16, 5, v16
    s_and_b32 s57, s49, 1
    s_lshl_b32 s56, s48, 4
    s_add_u32 s56, s56, s57
    s_lshl_b32 s56, s56, 4
    v_add_u32 v16, s56, v16
    s_cmp_ge_u32 s58, 2
    s_cbranch_scc1 f_lta
    s_mov_b32 s62, 4194304
    buffer_load_dword v7, v16, s[28:31], s62 offen sc1
f_lta:
    s_mov_b32 s59, 98304
    s_call_b64 s[0:1], f_isub
    s_waitcnt vmcnt(12)
    s_cmp_ge_u32 s58, 2
    s_cbranch_scc1 f_lp2
    s_mov_b32 s57, 50000
    s_branch f_pca
f_pla:
    s_mov_b32 s62, 4194304
    buffer_load_dword v7, v16, s[28:31], s62 offen sc1
    s_waitcnt vmcnt(0)
f_pca:
    v_cmp_eq_u32 vcc, s64, v7
    s_cmp_eq_u64 vcc, -1
    s_cbranch_scc1 f_pda
    s_sleep 12
    s_sub_u32 s57, s57, 1
    s_cmp_lg_u32 s57, 0
    s_cbranch_scc1 f_pla
f_pda:
    s_lshr_b32 s56, s97, 1
    s_cmp_eq_u32 s58, 1
    s_cbranch_scc1 f_lp3
    s_lshl_b32 s56, s56, 15
    s_and_b32 s57, s97, 1
    s_lshl_b32 s57, s57, 11
    s_add_u32 s56, s56, s57
    s_add_u32 s56, s56, s101
    buffer_load_dwordx4 v[152:155], v1, s[28:31], s56 offen sc1
    s_add_u32 s56, s56, 4096
    buffer_load_dwordx4 v[156:159], v1, s[28:31], s56 offen sc1
    s_add_u32 s56, s56, 4096
    buffer_load_dwordx4 v[160:163], v1, s[28:31], s56 offen sc1
    s_add_u32 s56, s56, 4096
    buffer_load_dwordx4 v[164:167], v1, s[28:31], s56 offen sc1
    s_add_u32 s56, s56, 4096
    buffer_load_dwordx4 v[168:171], v1, s[28:31], s56 offen sc1
    s_add_u32 s56, s56, 4096
    buffer_load_dwordx4 v[172:175], v1, s[28:31], s56 offen sc1
    s_add_u32 s56, s56, 4096
    buffer_load_dwordx4 v[176:179], v1, s[28:31], s56 offen sc1
    s_add_u32 s56, s56, 4096
    buffer_load_dwordx4 v[180:183], v1, s[28:31], s56 offen sc1
    s_branch f_lp2
f_lp3:
    s_lshl_b32 s57, s48, 2
    s_add_u32 s56, s56, s57
    s_lshl_b32 s56, s56, 11
    s_add_u32 s56, s56, 5242880
    buffer_load_dword v144, v132, s[28:31], s56 offen offset:0 sc1
    buffer_load_dword v145, v132, s[28:31], s56 offen offset:256 sc1
    buffer_load_dword v146, v132, s[28:31], s56 offen offset:512 sc1
    buffer_load_dword v147, v132, s[28:31], s56 offen offset:768 sc1
    buffer_load_dword v148, v132, s[28:31], s56 offen offset:1024 sc1
    buffer_load_dword v149, v132, s[28:31], s56 offen offset:1280 sc1
    buffer_load_dword v150, v132, s[28:31], s56 offen offset:1536 sc1
    buffer_load_dword v151, v132, s[28:31], s56 offen offset:1792 sc1
f_lp2:
    s_barrier
    s_mov_b32 s59, 49152
    s_call_b64 s[0:1], f_isub
    s_waitcnt vmcnt(12)
    s_lshl_b32 s56, s48, 2
    s_lshr_b32 s57, s97, 1
    s_add_u32 s56, s56, s57
    s_cmp_lg_u32 s14, 0
    s_cbranch_scc1 f_lgate
    v_mov_b32 v20, 0x3f80
    v_mov_b32 v21, 1.0
    v_dot2_f32_bf16 v144, v152, v20, 0
    v_dot2_f32_bf16 v145, v152, v21, 0
    v_dot2_f32_bf16 v146, v153, v20, 0
    v_dot2_f32_bf16 v147, v153, v21, 0
    v_dot2_f32_bf16 v148, v154, v20, 0
    v_dot2_f32_bf16 v149, v154, v21, 0
    v_dot2_f32_bf16 v150, v155, v20, 0
    v_dot2_f32_bf16 v151, v155, v21, 0
    v_dot2_f32_bf16 v144, v156, v20, v144
    v_dot2_f32_bf16 v145, v156, v21, v145
    v_dot2_f32_bf16 v146, v157, v20, v146
    v_dot2_f32_bf16 v147, v157, v21, v147
    v_dot2_f32_bf16 v148, v158, v20, v148
    v_dot2_f32_bf16 v149, v158, v21, v149
    v_dot2_f32_bf16 v150, v159, v20, v150
    v_dot2_f32_bf16 v151, v159, v21, v151
    v_dot2_f32_bf16 v144, v160, v20, v144
    v_dot2_f32_bf16 v145, v160, v21, v145
    v_dot2_f32_bf16 v146, v161, v20, v146
    v_dot2_f32_bf16 v147, v161, v21, v147
    v_dot2_f32_bf16 v148, v162, v20, v148
    v_dot2_f32_bf16 v149, v162, v21, v149
    v_dot2_f32_bf16 v150, v163, v20, v150
    v_dot2_f32_bf16 v151, v163, v21, v151
    v_dot2_f32_bf16 v144, v164, v20, v144
    v_dot2_f32_bf16 v145, v164, v21, v145
    v_dot2_f32_bf16 v146, v165, v20, v146
    v_dot2_f32_bf16 v147, v165, v21, v147
    v_dot2_f32_bf16 v148, v166, v20, v148
    v_dot2_f32_bf16 v149, v166, v21, v149
    v_dot2_f32_bf16 v150, v167, v20, v150
    v_dot2_f32_bf16 v151, v167, v21, v151
    v_dot2_f32_bf16 v144, v168, v20, v144
    v_dot2_f32_bf16 v145, v168, v21, v145
    v_dot2_f32_bf16 v146, v169, v20, v146
    v_dot2_f32_bf16 v147, v169, v21, v147
    v_dot2_f32_bf16 v148, v170, v20, v148
    v_dot2_f32_bf16 v149, v170, v21, v149
    v_dot2_f32_bf16 v150, v171, v20, v150
    v_dot2_f32_bf16 v151, v171, v21, v151
    v_dot2_f32_bf16 v144, v172, v20, v144
    v_dot2_f32_bf16 v145, v172, v21, v145
    v_dot2_f32_bf16 v146, v173, v20, v146
    v_dot2_f32_bf16 v147, v173, v21, v147
    v_dot2_f32_bf16 v148, v174, v20, v148
    v_dot2_f32_bf16 v149, v174, v21, v149
    v_dot2_f32_bf16 v150, v175, v20, v150
    v_dot2_f32_bf16 v151, v175, v21, v151
    v_dot2_f32_bf16 v144, v176, v20, v144
    v_dot2_f32_bf16 v145, v176, v21, v145
    v_dot2_f32_bf16 v146, v177, v20, v146
    v_dot2_f32_bf16 v147, v177, v21, v147
    v_dot2_f32_bf16 v148, v178, v20, v148
    v_dot2_f32_bf16 v149, v178, v21, v149
    v_dot2_f32_bf16 v150, v179, v20, v150
    v_dot2_f32_bf16 v151, v179, v21, v151
    v_dot2_f32_bf16 v144, v180, v20, v144
    v_dot2_f32_bf16 v145, v180, v21, v145
    v_dot2_f32_bf16 v146, v181, v20, v146
    v_dot2_f32_bf16 v147, v181, v21, v147
    v_dot2_f32_bf16 v148, v182, v20, v148
    v_dot2_f32_bf16 v149, v182, v21, v149
    v_dot2_f32_bf16 v150, v183, v20, v150
    v_dot2_f32_bf16 v151, v183, v21, v151
    s_nop 0
    s_cmp_eq_u32 s15, 0
    s_cselect_b32 s57, 1048744942, 1.0
    v_mul_f32 v144, s57, v144
    v_mul_f32 v145, s57, v145
    v_mul_f32 v146, s57, v146
    v_mul_f32 v147, s57, v147
    v_mul_f32 v148, s57, v148
    v_mul_f32 v149, s57, v149
    v_mul_f32 v150, s57, v150
    v_mul_f32 v151, s57, v151
    v_cvt_pk_bf16_f32 v208, v144, v145
    v_cvt_pk_bf16_f32 v209, v146, v147
    v_cvt_pk_bf16_f32 v210, v148, v149
    v_cvt_pk_bf16_f32 v211, v150, v151
    s_lshl_b32 s56, s56, 12
    s_lshl_b32 s57, s15, 11
    s_add_u32 s56, s56, s57
    s_and_b32 s57, s97, 1
    s_lshl_b32 s57, s57, 10
    s_add_u32 s56, s56, s57
    s_add_u32 s56, s56, 16777216
    buffer_store_dwordx4 v[208:211], v1, s[28:31], s56 offen sc1
    s_branch f_lsd
f_lgate:
    s_cmp_lg_u32 s58, 1
    s_cbranch_scc1 f_lsd
    v_add_f32 v144, v144, v145
    v_add_f32 v144, v144, v146
    v_add_f32 v144, v144, v147
    v_add_f32 v144, v144, v148
    v_add_f32 v144, v144, v149
    v_add_f32 v144, v144, v150
    v_add_f32 v144, v144, v151
    v_mov_b32 v145, v144
    s_lshl_b32 s56, s56, 7
    s_add_u32 s56, s56, 17039360
    v_permlane32_swap_b32 v144, v145
    v_and_b32 v16, 31, v0
    v_add_f32 v144, v144, v145
    v_mul_f32 v144, 3216550459, v144
    v_exp_f32 v144, v144
    v_lshlrev_b32 v16, 2, v16
    v_add_f32 v144, 1.0, v144
    v_rcp_f32 v144, v144
    s_nop 0
    buffer_store_dword v144, v16, s[28:31], s56 offen sc1
f_lsd:
    s_barrier
    s_add_u32 s98, s98, 4
    s_and_b32 s98, s98, 15
    s_mov_b32 s59, 0
    s_call_b64 s[0:1], f_isub
    s_waitcnt vmcnt(12)
    s_barrier
    s_cmp_lg_u32 s14, 0
    s_cbranch_scc1 f_ls11
    s_mov_b64 exec, 1
    v_mov_b32 v7, s64
    v_mov_b32 v17, 0
    s_lshl_b32 s56, s48, 4
    s_add_u32 s56, s56, s49
    s_lshl_b32 s56, s56, 4
    s_add_u32 s56, s56, 4198400
    buffer_store_dword v7, v17, s[28:31], s56 offen sc1
    s_mov_b64 exec, -1
f_ls11:
    s_mov_b32 s59, 98304
    s_call_b64 s[0:1], f_isub
    s_waitcnt vmcnt(12)
    s_barrier
    s_mov_b32 s59, 49152
    s_call_b64 s[0:1], f_isub
    s_waitcnt vmcnt(12)
    s_barrier
    s_mov_b32 s59, 0
    s_call_b64 s[0:1], f_isub
    s_waitcnt vmcnt(12)
    s_barrier
    v_lshlrev_b32 v16, 6, v0
    s_cmp_lg_u32 s14, 0
    s_cbranch_scc1 f_lt0
    s_mov_b32 s62, 4198400
    buffer_load_dword v7, v16, s[28:31], s62 offen sc1
    buffer_load_dword v17, v16, s[28:31], s62 offen offset:16 sc1
    buffer_load_dword v18, v16, s[28:31], s62 offen offset:32 sc1
    buffer_load_dword v19, v16, s[28:31], s62 offen offset:48 sc1
f_lt0:
    s_branch f_setv
f_setv_r:
    s_waitcnt vmcnt(0)
    s_cmp_lg_u32 s14, 0
    s_cbranch_scc1 f_pd0
    s_mov_b32 s57, 50000
    s_branch f_pc0
f_pl0:
    s_mov_b32 s62, 4198400
    buffer_load_dword v7, v16, s[28:31], s62 offen sc1
    buffer_load_dword v17, v16, s[28:31], s62 offen offset:16 sc1
    buffer_load_dword v18, v16, s[28:31], s62 offen offset:32 sc1
    buffer_load_dword v19, v16, s[28:31], s62 offen offset:48 sc1
    s_waitcnt vmcnt(0)
f_pc0:
    v_cmp_eq_u32 vcc, s64, v7
    s_mov_b64 s[62:63], vcc
    v_cmp_eq_u32 vcc, s64, v17
    s_and_b64 vcc, vcc, s[62:63]
    s_mov_b64 s[62:63], vcc
    v_cmp_eq_u32 vcc, s64, v18
    s_and_b64 vcc, vcc, s[62:63]
    s_mov_b64 s[62:63], vcc
    v_cmp_eq_u32 vcc, s64, v19
    s_and_b64 vcc, vcc, s[62:63]
    s_cmp_eq_u64 vcc, -1
    s_cbranch_scc1 f_pd0
    s_sleep 12
    s_sub_u32 s57, s57, 1
    s_cmp_lg_u32 s57, 0
    s_cbranch_scc1 f_pl0
f_pd0:
    s_barrier
    s_add_u32 m0, s100, 98304
    s_add_u32 s56, s100, 16777216
    buffer_load_dwordx4 v1, s[28:31], s56 offen offset:0 sc1 lds
    buffer_load_dwordx4 v1, s[28:31], s56 offen offset:1024 sc1 lds
    buffer_load_dwordx4 v1, s[28:31], s56 offen offset:2048 sc1 lds
    buffer_load_dwordx4 v1, s[28:31], s56 offen offset:3072 sc1 lds
    s_add_u32 m0, s100, 102400
    s_add_u32 s56, s100, 16781312
    buffer_load_dwordx4 v1, s[28:31], s56 offen offset:0 sc1 lds
    buffer_load_dwordx4 v1, s[28:31], s56 offen offset:1024 sc1 lds
    buffer_load_dwordx4 v1, s[28:31], s56 offen offset:2048 sc1 lds
    buffer_load_dwordx4 v1, s[28:31], s56 offen offset:3072 sc1 lds
    s_add_u32 m0, s100, 65536
    s_add_u32 s56, s100, 16809984
    buffer_load_dwordx4 v1, s[28:31], s56 offen offset:0 sc1 lds
    buffer_load_dwordx4 v1, s[28:31], s56 offen offset:1024 sc1 lds
    buffer_load_dwordx4 v1, s[28:31], s56 offen offset:2048 sc1 lds
    buffer_load_dwordx4 v1, s[28:31], s56 offen offset:3072 sc1 lds
    s_add_u32 m0, s100, 69632
    s_add_u32 s56, s100, 16814080
    buffer_load_dwordx4 v1, s[28:31], s56 offen offset:0 sc1 lds
    buffer_load_dwordx4 v1, s[28:31], s56 offen offset:1024 sc1 lds
    buffer_load_dwordx4 v1, s[28:31], s56 offen offset:2048 sc1 lds
    buffer_load_dwordx4 v1, s[28:31], s56 offen offset:3072 sc1 lds
    s_branch f_sets
f_sets_r:
    s_add_u32 s56, s99, 147456
    v_add_u32 v16, s56, v1
    s_setprio 0
    s_waitcnt vmcnt(0)
    s_barrier
    ds_read_b128 v[24:27], v16
    ds_read_b128 v[28:31], v16 offset:1024
    ds_read_b128 v[20:23], v16 offset:3072
    ds_read_b128 v[16:19], v16 offset:2048
f_attn:
    ds_read_b128 v[32:35], v2 offset:32768
    ds_read_b128 v[36:39], v2 offset:33792
    s_mov_b32 s40, s18
    s_mov_b32 s41, s19
    s_mov_b32 s42, 2097152
    s_mov_b32 s43, 0x20000
    s_waitcnt lgkmcnt(0)
    v_mfma_f32_32x32x16_bf16 v[64:79], v[32:35], v[24:27], 0
    v_mfma_f32_32x32x16_bf16 v[64:79], v[36:39], v[28:31], v[64:79]
    ds_read_b128 v[32:35], v2 offset:36864
    ds_read_b128 v[36:39], v2 offset:37888
    s_mov_b32 s36, s12
    s_mov_b32 s37, s13
    s_mov_b32 s38, 2097152
    s_mov_b32 s39, 0x20000
    v_mov_b32 v189, 4048155338
    v_mov_b32 v190, 0
    v_add_u32 v188, s79, v1
    v_add_u32 v191, 262144, v1
    s_waitcnt lgkmcnt(0)
    s_setprio 3
    v_mfma_f32_32x32x16_bf16 v[80:95], v[32:35], v[24:27], 0
    ds_read_b128 v[32:35], v2 offset:40960
    v_exp_f32 v64, v64
    v_exp_f32 v65, v65
    v_exp_f32 v66, v66
    v_exp_f32 v67, v67
    ds_read_b128 v[40:43], v2 offset:34816
    v_cvt_pk_bf16_f32 v48, v64, v65
    v_cvt_pk_bf16_f32 v49, v66, v67
    v_exp_f32 v68, v68
    v_exp_f32 v69, v69
    v_exp_f32 v70, v70
    v_mfma_f32_32x32x16_bf16 v[80:95], v[36:39], v[28:31], v[80:95]
    ds_read_b128 v[36:39], v2 offset:41984
    s_add_u32 m0, s74, 131072
    v_exp_f32 v71, v71
    v_cvt_pk_bf16_f32 v50, v68, v69
    v_exp_f32 v72, v72
    v_cvt_pk_bf16_f32 v51, v70, v71
    ds_read_b128 v[44:47], v2 offset:35840
    s_add_u32 s26, s74, 16842752
    v_exp_f32 v73, v73
    v_exp_f32 v74, v74
    v_cvt_pk_bf16_f32 v52, v72, v73
    v_exp_f32 v75, v75
    v_exp_f32 v76, v76
    v_cvt_pk_bf16_f32 v53, v74, v75
    v_exp_f32 v77, v77
    v_exp_f32 v78, v78
    v_exp_f32 v79, v79
    buffer_load_dwordx4 v1, s[28:31], s26 offen offset:0 sc1 lds
    s_waitcnt lgkmcnt(0)
    v_cvt_pk_bf16_f32 v54, v76, v77
    v_cvt_pk_bf16_f32 v55, v78, v79
    v_mfma_f32_32x32x16_bf16 v[64:79], v[32:35], v[24:27], 0
    ds_read_b128 v[32:35], v2 offset:45056
    v_exp_f32 v80, v80
    v_exp_f32 v81, v81
    v_exp_f32 v82, v82
    v_exp_f32 v83, v83
    v_mfma_f32_32x32x16_bf16 v[96:111], v[40:43], v[48:51], 0
    ds_read_b128 v[40:43], v2 offset:38912
    v_cvt_pk_bf16_f32 v56, v80, v81
    v_cvt_pk_bf16_f32 v57, v82, v83
    v_exp_f32 v84, v84
    v_exp_f32 v85, v85
    v_exp_f32 v86, v86
    v_mfma_f32_32x32x16_bf16 v[64:79], v[36:39], v[28:31], v[64:79]
    ds_read_b128 v[36:39], v2 offset:46080
    v_exp_f32 v87, v87
    v_cvt_pk_bf16_f32 v58, v84, v85
    v_exp_f32 v88, v88
    v_cvt_pk_bf16_f32 v59, v86, v87
    v_mfma_f32_32x32x16_bf16 v[96:111], v[44:47], v[52:55], v[96:111]
    ds_read_b128 v[44:47], v2 offset:39936
    v_exp_f32 v89, v89
    v_exp_f32 v90, v90
    v_cvt_pk_bf16_f32 v60, v88, v89
    v_exp_f32 v91, v91
    v_exp_f32 v92, v92
    v_cvt_pk_bf16_f32 v61, v90, v91
    v_exp_f32 v93, v93
    v_exp_f32 v94, v94
    v_exp_f32 v95, v95
    v_smfmac_f32_16x16x64_bf16 v[12:15], v[8:11], v[48:55], v5
    buffer_load_dwordx4 v1, s[28:31], s26 offen offset:1024 sc1 lds
    s_waitcnt lgkmcnt(0)
    v_cvt_pk_bf16_f32 v62, v92, v93
    v_cvt_pk_bf16_f32 v63, v94, v95
    v_mfma_f32_32x32x16_bf16 v[80:95], v[32:35], v[24:27], 0
    ds_read_b128 v[32:35], v2 offset:49152
    v_exp_f32 v64, v64
    v_exp_f32 v65, v65
    v_exp_f32 v66, v66
    v_exp_f32 v67, v67
    v_mfma_f32_32x32x16_bf16 v[96:111], v[40:43], v[56:59], v[96:111]
    ds_read_b128 v[40:43], v2 offset:43008
    v_cvt_pk_bf16_f32 v48, v64, v65
    v_cvt_pk_bf16_f32 v49, v66, v67
    v_exp_f32 v68, v68
    v_exp_f32 v69, v69
    v_exp_f32 v70, v70
    v_mfma_f32_32x32x16_bf16 v[80:95], v[36:39], v[28:31], v[80:95]
    ds_read_b128 v[36:39], v2 offset:50176
    v_exp_f32 v71, v71
    v_cvt_pk_bf16_f32 v50, v68, v69
    v_exp_f32 v72, v72
    v_cvt_pk_bf16_f32 v51, v70, v71
    v_mfma_f32_32x32x16_bf16 v[96:111], v[44:47], v[60:63], v[96:111]
    ds_read_b128 v[44:47], v2 offset:44032
    v_exp_f32 v73, v73
    v_exp_f32 v74, v74
    v_cvt_pk_bf16_f32 v52, v72, v73
    v_exp_f32 v75, v75
    v_exp_f32 v76, v76
    v_cvt_pk_bf16_f32 v53, v74, v75
    v_exp_f32 v77, v77
    v_exp_f32 v78, v78
    v_exp_f32 v79, v79
    v_smfmac_f32_16x16x64_bf16 v[12:15], v[8:11], v[56:63], v5
    buffer_load_dwordx4 v1, s[28:31], s26 offen offset:2048 sc1 lds
    s_waitcnt lgkmcnt(0)
    v_cvt_pk_bf16_f32 v54, v76, v77
    v_cvt_pk_bf16_f32 v55, v78, v79
    v_mfma_f32_32x32x16_bf16 v[64:79], v[32:35], v[24:27], 0
    ds_read_b128 v[32:35], v2 offset:53248
    v_exp_f32 v80, v80
    v_exp_f32 v81, v81
    v_exp_f32 v82, v82
    v_exp_f32 v83, v83
    v_mfma_f32_32x32x16_bf16 v[96:111], v[40:43], v[48:51], v[96:111]
    ds_read_b128 v[40:43], v2 offset:47104
    v_cvt_pk_bf16_f32 v56, v80, v81
    v_cvt_pk_bf16_f32 v57, v82, v83
    v_exp_f32 v84, v84
    v_exp_f32 v85, v85
    v_exp_f32 v86, v86
    v_mfma_f32_32x32x16_bf16 v[64:79], v[36:39], v[28:31], v[64:79]
    ds_read_b128 v[36:39], v2 offset:54272
    v_exp_f32 v87, v87
    v_cvt_pk_bf16_f32 v58, v84, v85
    v_exp_f32 v88, v88
    v_cvt_pk_bf16_f32 v59, v86, v87
    v_mfma_f32_32x32x16_bf16 v[96:111], v[44:47], v[52:55], v[96:111]
    ds_read_b128 v[44:47], v2 offset:48128
    v_exp_f32 v89, v89
    v_exp_f32 v90, v90
    v_cvt_pk_bf16_f32 v60, v88, v89
    v_exp_f32 v91, v91
    v_exp_f32 v92, v92
    v_cvt_pk_bf16_f32 v61, v90, v91
    v_exp_f32 v93, v93
    v_exp_f32 v94, v94
    v_exp_f32 v95, v95
    v_smfmac_f32_16x16x64_bf16 v[12:15], v[8:11], v[48:55], v5
    buffer_load_dwordx4 v1, s[28:31], s26 offen offset:3072 sc1 lds
    s_waitcnt lgkmcnt(0)
    v_cvt_pk_bf16_f32 v62, v92, v93
    v_cvt_pk_bf16_f32 v63, v94, v95
    v_mfma_f32_32x32x16_bf16 v[80:95], v[32:35], v[24:27], 0
    ds_read_b128 v[32:35], v2 offset:57344
    v_exp_f32 v64, v64
    v_exp_f32 v65, v65
    v_exp_f32 v66, v66
    v_exp_f32 v67, v67
    v_mfma_f32_32x32x16_bf16 v[96:111], v[40:43], v[56:59], v[96:111]
    ds_read_b128 v[40:43], v2 offset:51200
    v_cvt_pk_bf16_f32 v48, v64, v65
    v_cvt_pk_bf16_f32 v49, v66, v67
    v_exp_f32 v68, v68
    v_exp_f32 v69, v69
    v_exp_f32 v70, v70
    v_mfma_f32_32x32x16_bf16 v[80:95], v[36:39], v[28:31], v[80:95]
    ds_read_b128 v[36:39], v2 offset:58368
    v_exp_f32 v71, v71
    v_cvt_pk_bf16_f32 v50, v68, v69
    v_exp_f32 v72, v72
    v_cvt_pk_bf16_f32 v51, v70, v71
    v_mfma_f32_32x32x16_bf16 v[96:111], v[44:47], v[60:63], v[96:111]
    ds_read_b128 v[44:47], v2 offset:52224
    v_exp_f32 v73, v73
    v_exp_f32 v74, v74
    v_cvt_pk_bf16_f32 v52, v72, v73
    v_fma_f32 v148, -v112, s16, v189
    v_fma_f32 v149, -v113, s16, v189
    v_fma_f32 v150, -v114, s16, v189
    v_fma_f32 v151, -v115, s16, v189
    v_exp_f32 v75, v75
    v_exp_f32 v76, v76
    v_cvt_pk_bf16_f32 v53, v74, v75
    v_exp_f32 v77, v77
    v_exp_f32 v78, v78
    v_exp_f32 v79, v79
    v_smfmac_f32_16x16x64_bf16 v[12:15], v[8:11], v[56:63], v5
    s_waitcnt lgkmcnt(0)
    v_cvt_pk_bf16_f32 v54, v76, v77
    v_cvt_pk_bf16_f32 v55, v78, v79
    v_mfma_f32_32x32x16_bf16 v[64:79], v[32:35], v[24:27], 0
    ds_read_b128 v[32:35], v2 offset:61440
    v_exp_f32 v80, v80
    v_exp_f32 v81, v81
    v_exp_f32 v82, v82
    v_exp_f32 v83, v83
    v_mfma_f32_32x32x16_bf16 v[96:111], v[40:43], v[48:51], v[96:111]
    ds_read_b128 v[40:43], v2 offset:55296
    v_cvt_pk_bf16_f32 v56, v80, v81
    v_cvt_pk_bf16_f32 v57, v82, v83
    v_exp_f32 v84, v84
    v_exp_f32 v85, v85
    v_exp_f32 v86, v86
    v_mfma_f32_32x32x16_bf16 v[64:79], v[36:39], v[28:31], v[64:79]
    ds_read_b128 v[36:39], v2 offset:62464
    v_exp_f32 v87, v87
    v_cvt_pk_bf16_f32 v58, v84, v85
    v_exp_f32 v88, v88
    v_cvt_pk_bf16_f32 v59, v86, v87
    v_mfma_f32_32x32x16_bf16 v[96:111], v[44:47], v[52:55], v[96:111]
    ds_read_b128 v[44:47], v2 offset:56320
    v_exp_f32 v89, v89
    v_exp_f32 v90, v90
    v_cvt_pk_bf16_f32 v60, v88, v89
    v_fma_f32 v152, -v116, s16, v189
    v_fma_f32 v153, -v117, s16, v189
    v_fma_f32 v154, -v118, s16, v189
    v_fma_f32 v155, -v119, s16, v189
    v_exp_f32 v91, v91
    v_exp_f32 v92, v92
    v_cvt_pk_bf16_f32 v61, v90, v91
    v_exp_f32 v93, v93
    v_exp_f32 v94, v94
    v_exp_f32 v95, v95
    v_smfmac_f32_16x16x64_bf16 v[12:15], v[8:11], v[48:55], v5
    s_waitcnt lgkmcnt(0)
    v_cvt_pk_bf16_f32 v62, v92, v93
    v_cvt_pk_bf16_f32 v63, v94, v95
    s_setprio 2
    v_mfma_f32_32x32x16_bf16 v[80:95], v[32:35], v[24:27], 0
    ds_read_b128 v[32:35], v2 offset:0
    v_exp_f32 v64, v64
    v_exp_f32 v65, v65
    v_exp_f32 v66, v66
    v_exp_f32 v67, v67
    v_mfma_f32_32x32x16_bf16 v[96:111], v[40:43], v[56:59], v[96:111]
    ds_read_b128 v[40:43], v2 offset:59392
    v_cvt_pk_bf16_f32 v48, v64, v65
    v_cvt_pk_bf16_f32 v49, v66, v67
    v_exp_f32 v68, v68
    v_exp_f32 v69, v69
    v_exp_f32 v70, v70
    v_mfma_f32_32x32x16_bf16 v[80:95], v[36:39], v[28:31], v[80:95]
    ds_read_b128 v[36:39], v2 offset:1024
    v_exp_f32 v71, v71
    v_cvt_pk_bf16_f32 v50, v68, v69
    v_exp_f32 v72, v72
    v_cvt_pk_bf16_f32 v51, v70, v71
    v_mfma_f32_32x32x16_bf16 v[96:111], v[44:47], v[60:63], v[96:111]
    ds_read_b128 v[44:47], v2 offset:60416
    v_exp_f32 v73, v73
    v_exp_f32 v74, v74
    v_cvt_pk_bf16_f32 v52, v72, v73
    v_fma_f32 v156, -v120, s16, v189
    v_fma_f32 v157, -v121, s16, v189
    v_fma_f32 v158, -v122, s16, v189
    v_fma_f32 v159, -v123, s16, v189
    v_exp_f32 v75, v75
    v_exp_f32 v76, v76
    v_cvt_pk_bf16_f32 v53, v74, v75
    v_exp_f32 v77, v77
    v_exp_f32 v78, v78
    v_exp_f32 v79, v79
    v_smfmac_f32_16x16x64_bf16 v[12:15], v[8:11], v[56:63], v5
    s_waitcnt lgkmcnt(0)
    v_cvt_pk_bf16_f32 v54, v76, v77
    v_cvt_pk_bf16_f32 v55, v78, v79
    v_mfma_f32_32x32x16_bf16 v[64:79], v[32:35], v[24:27], 0
    ds_read_b128 v[32:35], v2 offset:4096
    v_exp_f32 v80, v80
    v_exp_f32 v81, v81
    v_exp_f32 v82, v82
    v_exp_f32 v83, v83
    v_mfma_f32_32x32x16_bf16 v[96:111], v[40:43], v[48:51], v[96:111]
    ds_read_b128 v[40:43], v2 offset:63488
    v_cvt_pk_bf16_f32 v56, v80, v81
    v_cvt_pk_bf16_f32 v57, v82, v83
    v_exp_f32 v84, v84
    v_exp_f32 v85, v85
    v_exp_f32 v86, v86
    v_mfma_f32_32x32x16_bf16 v[64:79], v[36:39], v[28:31], v[64:79]
    ds_read_b128 v[36:39], v2 offset:5120
    v_exp_f32 v87, v87
    v_cvt_pk_bf16_f32 v58, v84, v85
    v_exp_f32 v88, v88
    v_cvt_pk_bf16_f32 v59, v86, v87
    v_mfma_f32_32x32x16_bf16 v[96:111], v[44:47], v[52:55], v[96:111]
    ds_read_b128 v[44:47], v2 offset:64512
    v_exp_f32 v89, v89
    v_exp_f32 v90, v90
    v_cvt_pk_bf16_f32 v60, v88, v89
    v_fma_f32 v160, -v124, s16, v189
    v_fma_f32 v161, -v125, s16, v189
    v_fma_f32 v162, -v126, s16, v189
    v_fma_f32 v163, -v127, s16, v189
    v_exp_f32 v91, v91
    v_exp_f32 v92, v92
    v_cvt_pk_bf16_f32 v61, v90, v91
    v_exp_f32 v93, v93
    v_exp_f32 v94, v94
    v_exp_f32 v95, v95
    v_smfmac_f32_16x16x64_bf16 v[12:15], v[8:11], v[48:55], v5
    s_waitcnt lgkmcnt(0)
    v_cvt_pk_bf16_f32 v62, v92, v93
    v_cvt_pk_bf16_f32 v63, v94, v95
    v_mfma_f32_32x32x16_bf16 v[80:95], v[32:35], v[24:27], 0
    ds_read_b128 v[32:35], v2 offset:8192
    v_exp_f32 v64, v64
    v_exp_f32 v65, v65
    v_exp_f32 v66, v66
    v_exp_f32 v67, v67
    v_mfma_f32_32x32x16_bf16 v[96:111], v[40:43], v[56:59], v[96:111]
    ds_read_b128 v[40:43], v2 offset:2048
    v_cvt_pk_bf16_f32 v48, v64, v65
    v_cvt_pk_bf16_f32 v49, v66, v67
    v_exp_f32 v68, v68
    v_exp_f32 v69, v69
    v_exp_f32 v70, v70
    v_mfma_f32_32x32x16_bf16 v[80:95], v[36:39], v[28:31], v[80:95]
    ds_read_b128 v[36:39], v2 offset:9216
    v_exp_f32 v71, v71
    v_cvt_pk_bf16_f32 v50, v68, v69
    v_exp_f32 v72, v72
    v_cvt_pk_bf16_f32 v51, v70, v71
    v_mfma_f32_32x32x16_bf16 v[96:111], v[44:47], v[60:63], v[96:111]
    ds_read_b128 v[44:47], v2 offset:3072
    v_exp_f32 v73, v73
    v_exp_f32 v74, v74
    v_cvt_pk_bf16_f32 v52, v72, v73
    v_exp_f32 v75, v75
    v_exp_f32 v76, v76
    v_cvt_pk_bf16_f32 v53, v74, v75
    v_exp_f32 v77, v77
    v_exp_f32 v78, v78
    v_exp_f32 v79, v79
    v_smfmac_f32_16x16x64_bf16 v[12:15], v[8:11], v[56:63], v5
    s_waitcnt lgkmcnt(0)
    v_cvt_pk_bf16_f32 v54, v76, v77
    v_cvt_pk_bf16_f32 v55, v78, v79
    v_mfma_f32_32x32x16_bf16 v[64:79], v[32:35], v[24:27], 0
    ds_read_b128 v[32:35], v2 offset:12288
    v_exp_f32 v80, v80
    v_exp_f32 v81, v81
    v_exp_f32 v82, v82
    v_exp_f32 v83, v83
    v_mfma_f32_32x32x16_bf16 v[96:111], v[40:43], v[48:51], v[96:111]
    ds_read_b128 v[40:43], v2 offset:6144
    v_cvt_pk_bf16_f32 v56, v80, v81
    v_cvt_pk_bf16_f32 v57, v82, v83
    v_exp_f32 v84, v84
    v_exp_f32 v85, v85
    v_exp_f32 v86, v86
    v_mfma_f32_32x32x16_bf16 v[64:79], v[36:39], v[28:31], v[64:79]
    ds_read_b128 v[36:39], v2 offset:13312
    v_exp_f32 v87, v87
    v_cvt_pk_bf16_f32 v58, v84, v85
    v_exp_f32 v88, v88
    v_cvt_pk_bf16_f32 v59, v86, v87
    v_mfma_f32_32x32x16_bf16 v[96:111], v[44:47], v[52:55], v[96:111]
    ds_read_b128 v[44:47], v2 offset:7168
    v_exp_f32 v89, v89
    v_exp_f32 v90, v90
    v_cvt_pk_bf16_f32 v60, v88, v89
    v_exp_f32 v91, v91
    v_exp_f32 v92, v92
    v_cvt_pk_bf16_f32 v61, v90, v91
    v_exp_f32 v93, v93
    v_exp_f32 v94, v94
    v_exp_f32 v95, v95
    v_smfmac_f32_16x16x64_bf16 v[12:15], v[8:11], v[48:55], v5
    s_waitcnt lgkmcnt(0)
    v_cvt_pk_bf16_f32 v62, v92, v93
    v_cvt_pk_bf16_f32 v63, v94, v95
    v_mfma_f32_32x32x16_bf16 v[80:95], v[32:35], v[24:27], 0
    ds_read_b128 v[32:35], v2 offset:16384
    v_exp_f32 v64, v64
    v_exp_f32 v65, v65
    v_exp_f32 v66, v66
    v_exp_f32 v67, v67
    v_mfma_f32_32x32x16_bf16 v[96:111], v[40:43], v[56:59], v[96:111]
    ds_read_b128 v[40:43], v2 offset:10240
    v_cvt_pk_bf16_f32 v48, v64, v65
    v_cvt_pk_bf16_f32 v49, v66, v67
    v_exp_f32 v68, v68
    v_exp_f32 v69, v69
    v_exp_f32 v70, v70
    v_mfma_f32_32x32x16_bf16 v[80:95], v[36:39], v[28:31], v[80:95]
    ds_read_b128 v[36:39], v2 offset:17408
    v_exp_f32 v71, v71
    v_cvt_pk_bf16_f32 v50, v68, v69
    v_exp_f32 v72, v72
    v_cvt_pk_bf16_f32 v51, v70, v71
    v_mfma_f32_32x32x16_bf16 v[96:111], v[44:47], v[60:63], v[96:111]
    ds_read_b128 v[44:47], v2 offset:11264
    v_exp_f32 v73, v73
    v_exp_f32 v74, v74
    v_cvt_pk_bf16_f32 v52, v72, v73
    v_exp_f32 v75, v75
    v_exp_f32 v76, v76
    v_cvt_pk_bf16_f32 v53, v74, v75
    v_exp_f32 v77, v77
    v_exp_f32 v78, v78
    v_exp_f32 v79, v79
    v_smfmac_f32_16x16x64_bf16 v[12:15], v[8:11], v[56:63], v5
    s_waitcnt lgkmcnt(0)
    v_cvt_pk_bf16_f32 v54, v76, v77
    v_cvt_pk_bf16_f32 v55, v78, v79
    v_mfma_f32_32x32x16_bf16 v[64:79], v[32:35], v[24:27], 0
    ds_read_b128 v[32:35], v2 offset:20480
    v_exp_f32 v80, v80
    v_exp_f32 v81, v81
    v_exp_f32 v82, v82
    v_exp_f32 v83, v83
    v_mfma_f32_32x32x16_bf16 v[96:111], v[40:43], v[48:51], v[96:111]
    ds_read_b128 v[40:43], v2 offset:14336
    v_cvt_pk_bf16_f32 v56, v80, v81
    v_cvt_pk_bf16_f32 v57, v82, v83
    v_exp_f32 v84, v84
    v_exp_f32 v85, v85
    v_exp_f32 v86, v86
    v_mfma_f32_32x32x16_bf16 v[64:79], v[36:39], v[28:31], v[64:79]
    ds_read_b128 v[36:39], v2 offset:21504
    v_exp_f32 v87, v87
    v_cvt_pk_bf16_f32 v58, v84, v85
    v_exp_f32 v88, v88
    v_cvt_pk_bf16_f32 v59, v86, v87
    v_mfma_f32_32x32x16_bf16 v[96:111], v[44:47], v[52:55], v[96:111]
    ds_read_b128 v[44:47], v2 offset:15360
    v_exp_f32 v89, v89
    v_exp_f32 v90, v90
    v_cvt_pk_bf16_f32 v60, v88, v89
    v_exp_f32 v91, v91
    v_exp_f32 v92, v92
    v_cvt_pk_bf16_f32 v61, v90, v91
    v_exp_f32 v93, v93
    v_exp_f32 v94, v94
    v_exp_f32 v95, v95
    v_smfmac_f32_16x16x64_bf16 v[12:15], v[8:11], v[48:55], v5
    s_waitcnt lgkmcnt(0)
    v_cvt_pk_bf16_f32 v62, v92, v93
    v_cvt_pk_bf16_f32 v63, v94, v95
    s_waitcnt vmcnt(0)
    s_barrier
    s_cmp_eq_u32 s3, 4
    s_cbranch_scc1 f_sig1
f_sig1_r:
    s_setprio 3
    v_mfma_f32_32x32x16_bf16 v[80:95], v[32:35], v[24:27], 0
    ds_read_b128 v[32:35], v2 offset:24576
    v_exp_f32 v64, v64
    v_exp_f32 v65, v65
    v_exp_f32 v66, v66
    v_exp_f32 v67, v67
    v_mfma_f32_32x32x16_bf16 v[96:111], v[40:43], v[56:59], v[96:111]
    ds_read_b128 v[40:43], v2 offset:18432
    s_add_u32 m0, s74, 98304
    v_cvt_pk_bf16_f32 v48, v64, v65
    v_cvt_pk_bf16_f32 v49, v66, v67
    v_exp_f32 v68, v68
    v_exp_f32 v69, v69
    v_exp_f32 v70, v70
    v_mfma_f32_32x32x16_bf16 v[80:95], v[36:39], v[28:31], v[80:95]
    ds_read_b128 v[36:39], v2 offset:25600
    s_add_u32 s26, s74, 16875520
    v_exp_f32 v71, v71
    v_cvt_pk_bf16_f32 v50, v68, v69
    v_exp_f32 v72, v72
    v_cvt_pk_bf16_f32 v51, v70, v71
    v_mfma_f32_32x32x16_bf16 v[96:111], v[44:47], v[60:63], v[96:111]
    ds_read_b128 v[44:47], v2 offset:19456
    buffer_load_dwordx4 v1, s[28:31], s26 offen offset:0 sc1 lds
    v_exp_f32 v73, v73
    v_exp_f32 v74, v74
    v_cvt_pk_bf16_f32 v52, v72, v73
    v_mov_b32 v164, s17
    v_mov_b32 v165, s17
    v_mov_b32 v166, s17
    v_mov_b32 v167, s17
    v_mov_b32 v144, 0
    v_exp_f32 v75, v75
    v_exp_f32 v76, v76
    v_cvt_pk_bf16_f32 v53, v74, v75
    v_exp_f32 v77, v77
    v_exp_f32 v78, v78
    v_exp_f32 v79, v79
    v_smfmac_f32_16x16x64_bf16 v[12:15], v[8:11], v[56:63], v5
    buffer_load_dwordx4 v1, s[28:31], s26 offen offset:1024 sc1 lds
    s_waitcnt lgkmcnt(0)
    v_cvt_pk_bf16_f32 v54, v76, v77
    v_cvt_pk_bf16_f32 v55, v78, v79
    v_mfma_f32_32x32x16_bf16 v[64:79], v[32:35], v[24:27], 0
    ds_read_b128 v[32:35], v2 offset:28672
    v_exp_f32 v80, v80
    v_exp_f32 v81, v81
    v_exp_f32 v82, v82
    v_exp_f32 v83, v83
    v_mfma_f32_32x32x16_bf16 v[96:111], v[40:43], v[48:51], v[96:111]
    ds_read_b128 v[40:43], v2 offset:22528
    v_cvt_pk_bf16_f32 v56, v80, v81
    v_cvt_pk_bf16_f32 v57, v82, v83
    v_exp_f32 v84, v84
    v_exp_f32 v85, v85
    v_exp_f32 v86, v86
    v_mfma_f32_32x32x16_bf16 v[64:79], v[36:39], v[28:31], v[64:79]
    ds_read_b128 v[36:39], v2 offset:29696
    v_exp_f32 v87, v87
    v_cvt_pk_bf16_f32 v58, v84, v85
    v_exp_f32 v88, v88
    v_cvt_pk_bf16_f32 v59, v86, v87
    v_mfma_f32_32x32x16_bf16 v[96:111], v[44:47], v[52:55], v[96:111]
    ds_read_b128 v[44:47], v2 offset:23552
    buffer_load_dwordx4 v1, s[28:31], s26 offen offset:2048 sc1 lds
    v_exp_f32 v89, v89
    v_exp_f32 v90, v90
    v_cvt_pk_bf16_f32 v60, v88, v89
    v_mov_b32 v168, s17
    v_mov_b32 v169, s17
    v_mov_b32 v170, s17
    v_mov_b32 v171, s17
    v_mov_b32 v145, 0
    v_exp_f32 v91, v91
    v_exp_f32 v92, v92
    v_cvt_pk_bf16_f32 v61, v90, v91
    v_exp_f32 v93, v93
    v_exp_f32 v94, v94
    v_exp_f32 v95, v95
    v_smfmac_f32_16x16x64_bf16 v[12:15], v[8:11], v[48:55], v5
    buffer_load_dwordx4 v1, s[28:31], s26 offen offset:3072 sc1 lds
    s_waitcnt lgkmcnt(0)
    v_cvt_pk_bf16_f32 v62, v92, v93
    v_cvt_pk_bf16_f32 v63, v94, v95
    v_mfma_f32_32x32x16_bf16 v[80:95], v[32:35], v[24:27], 0
    ds_read_b128 v[32:35], v3 offset:0
    v_exp_f32 v64, v64
    v_exp_f32 v65, v65
    v_exp_f32 v66, v66
    v_exp_f32 v67, v67
    v_mfma_f32_32x32x16_bf16 v[96:111], v[40:43], v[56:59], v[96:111]
    ds_read_b128 v[40:43], v2 offset:26624
    v_cvt_pk_bf16_f32 v48, v64, v65
    v_cvt_pk_bf16_f32 v49, v66, v67
    v_exp_f32 v68, v68
    v_exp_f32 v69, v69
    v_exp_f32 v70, v70
    v_mfma_f32_32x32x16_bf16 v[80:95], v[36:39], v[28:31], v[80:95]
    ds_read_b128 v[36:39], v3 offset:1024
    v_exp_f32 v71, v71
    v_cvt_pk_bf16_f32 v50, v68, v69
    v_exp_f32 v72, v72
    v_cvt_pk_bf16_f32 v51, v70, v71
    v_mfma_f32_32x32x16_bf16 v[96:111], v[44:47], v[60:63], v[96:111]
    ds_read_b128 v[44:47], v2 offset:27648
    v_exp_f32 v73, v73
    v_exp_f32 v74, v74
    v_cvt_pk_bf16_f32 v52, v72, v73
    v_mov_b32 v172, s17
    v_mov_b32 v173, s17
    v_mov_b32 v174, s17
    v_mov_b32 v175, s17
    v_mov_b32 v146, 0
    v_exp_f32 v75, v75
    v_exp_f32 v76, v76
    v_cvt_pk_bf16_f32 v53, v74, v75
    v_exp_f32 v77, v77
    v_exp_f32 v78, v78
    v_exp_f32 v79, v79
    v_smfmac_f32_16x16x64_bf16 v[12:15], v[8:11], v[56:63], v5
    s_waitcnt lgkmcnt(0)
    v_cvt_pk_bf16_f32 v54, v76, v77
    v_cvt_pk_bf16_f32 v55, v78, v79
    s_setprio 2
    v_mfma_f32_32x32x16_bf16 v[64:79], v[32:35], v[24:27], 0
    ds_read_b128 v[32:35], v3 offset:4096
    v_exp_f32 v80, v80
    v_exp_f32 v81, v81
    v_exp_f32 v82, v82
    v_exp_f32 v83, v83
    v_mfma_f32_32x32x16_bf16 v[96:111], v[40:43], v[48:51], v[96:111]
    ds_read_b128 v[40:43], v2 offset:30720
    v_cvt_pk_bf16_f32 v56, v80, v81
    v_cvt_pk_bf16_f32 v57, v82, v83
    v_exp_f32 v84, v84
    v_exp_f32 v85, v85
    v_exp_f32 v86, v86
    v_mfma_f32_32x32x16_bf16 v[64:79], v[36:39], v[28:31], v[64:79]
    ds_read_b128 v[36:39], v3 offset:5120
    v_exp_f32 v87, v87
    v_cvt_pk_bf16_f32 v58, v84, v85
    v_exp_f32 v88, v88
    v_cvt_pk_bf16_f32 v59, v86, v87
    v_mfma_f32_32x32x16_bf16 v[96:111], v[44:47], v[52:55], v[96:111]
    ds_read_b128 v[44:47], v2 offset:31744
    v_exp_f32 v89, v89
    v_exp_f32 v90, v90
    v_cvt_pk_bf16_f32 v60, v88, v89
    v_mov_b32 v176, s17
    v_mov_b32 v177, s17
    v_mov_b32 v178, s17
    v_mov_b32 v179, s17
    v_mov_b32 v147, 0
    v_exp_f32 v91, v91
    v_exp_f32 v92, v92
    v_cvt_pk_bf16_f32 v61, v90, v91
    v_exp_f32 v93, v93
    v_exp_f32 v94, v94
    v_exp_f32 v95, v95
    v_smfmac_f32_16x16x64_bf16 v[12:15], v[8:11], v[48:55], v5
    s_waitcnt lgkmcnt(0)
    v_cvt_pk_bf16_f32 v62, v92, v93
    v_cvt_pk_bf16_f32 v63, v94, v95
    s_cmp_eq_u32 s3, 4
    s_cbranch_scc1 f_pre1
f_pre1_r:
    v_mfma_f32_32x32x16_bf16 v[80:95], v[32:35], v[24:27], 0
    ds_read_b128 v[32:35], v3 offset:8192
    v_exp_f32 v64, v64
    v_exp_f32 v65, v65
    v_exp_f32 v66, v66
    v_exp_f32 v67, v67
    v_mfma_f32_32x32x16_bf16 v[96:111], v[40:43], v[56:59], v[96:111]
    ds_read_b128 v[40:43], v3 offset:2048
    v_cvt_pk_bf16_f32 v48, v64, v65
    v_cvt_pk_bf16_f32 v49, v66, v67
    v_exp_f32 v68, v68
    v_exp_f32 v69, v69
    v_exp_f32 v70, v70
    v_mfma_f32_32x32x16_bf16 v[80:95], v[36:39], v[28:31], v[80:95]
    ds_read_b128 v[36:39], v3 offset:9216
    v_exp_f32 v71, v71
    v_cvt_pk_bf16_f32 v50, v68, v69
    v_exp_f32 v72, v72
    v_cvt_pk_bf16_f32 v51, v70, v71
    v_mfma_f32_32x32x16_bf16 v[96:111], v[44:47], v[60:63], v[96:111]
    ds_read_b128 v[44:47], v3 offset:3072
    v_exp_f32 v73, v73
    v_exp_f32 v74, v74
    v_cvt_pk_bf16_f32 v52, v72, v73
    v_exp_f32 v75, v75
    v_exp_f32 v76, v76
    v_cvt_pk_bf16_f32 v53, v74, v75
    v_exp_f32 v77, v77
    v_exp_f32 v78, v78
    v_exp_f32 v79, v79
    v_smfmac_f32_16x16x64_bf16 v[12:15], v[8:11], v[56:63], v5
    s_waitcnt lgkmcnt(0)
    v_cvt_pk_bf16_f32 v54, v76, v77
    v_cvt_pk_bf16_f32 v55, v78, v79
    v_mfma_f32_32x32x16_bf16 v[64:79], v[32:35], v[24:27], 0
    ds_read_b128 v[32:35], v3 offset:12288
    v_exp_f32 v80, v80
    v_exp_f32 v81, v81
    v_exp_f32 v82, v82
    v_exp_f32 v83, v83
    v_mfma_f32_32x32x16_bf16 v[96:111], v[40:43], v[48:51], v[96:111]
    ds_read_b128 v[40:43], v3 offset:6144
    v_cvt_pk_bf16_f32 v56, v80, v81
    v_cvt_pk_bf16_f32 v57, v82, v83
    v_exp_f32 v84, v84
    v_exp_f32 v85, v85
    v_exp_f32 v86, v86
    v_mfma_f32_32x32x16_bf16 v[64:79], v[36:39], v[28:31], v[64:79]
    ds_read_b128 v[36:39], v3 offset:13312
    v_exp_f32 v87, v87
    v_cvt_pk_bf16_f32 v58, v84, v85
    v_exp_f32 v88, v88
    v_cvt_pk_bf16_f32 v59, v86, v87
    v_mfma_f32_32x32x16_bf16 v[96:111], v[44:47], v[52:55], v[96:111]
    ds_read_b128 v[44:47], v3 offset:7168
    v_exp_f32 v89, v89
    v_exp_f32 v90, v90
    v_cvt_pk_bf16_f32 v60, v88, v89
    v_exp_f32 v91, v91
    v_exp_f32 v92, v92
    v_cvt_pk_bf16_f32 v61, v90, v91
    v_exp_f32 v93, v93
    v_exp_f32 v94, v94
    v_exp_f32 v95, v95
    v_smfmac_f32_16x16x64_bf16 v[12:15], v[8:11], v[48:55], v5
    s_waitcnt lgkmcnt(0)
    v_cvt_pk_bf16_f32 v62, v92, v93
    v_cvt_pk_bf16_f32 v63, v94, v95
    s_cmp_eq_u32 s3, 4
    s_cbranch_scc1 f_poll1
f_poll1_r:
    s_waitcnt vmcnt(0)
    s_barrier
    s_setprio 3
    v_mfma_f32_32x32x16_bf16 v[80:95], v[32:35], v[24:27], 0
    ds_read_b128 v[32:35], v3 offset:16384
    v_exp_f32 v64, v64
    v_exp_f32 v65, v65
    v_exp_f32 v66, v66
    v_exp_f32 v67, v67
    v_mfma_f32_32x32x16_bf16 v[96:111], v[40:43], v[56:59], v[96:111]
    ds_read_b128 v[40:43], v3 offset:10240
    s_add_u32 m0, s75, 0
    v_cvt_pk_bf16_f32 v48, v64, v65
    v_cvt_pk_bf16_f32 v49, v66, v67
    v_exp_f32 v68, v68
    v_exp_f32 v69, v69
    v_exp_f32 v70, v70
    v_mfma_f32_32x32x16_bf16 v[80:95], v[36:39], v[28:31], v[80:95]
    ds_read_b128 v[36:39], v3 offset:17408
    buffer_load_dwordx4 v1, s[28:31], s80 offen sc1 lds
    v_exp_f32 v71, v71
    v_cvt_pk_bf16_f32 v50, v68, v69
    v_exp_f32 v72, v72
    v_cvt_pk_bf16_f32 v51, v70, v71
    v_mfma_f32_32x32x16_bf16 v[96:111], v[44:47], v[60:63], v[96:111]
    ds_read_b128 v[44:47], v3 offset:11264
    s_add_u32 m0, s75, 8192
    v_exp_f32 v73, v73
    v_exp_f32 v74, v74
    v_cvt_pk_bf16_f32 v52, v72, v73
    v_exp_f32 v75, v75
    v_exp_f32 v76, v76
    v_cvt_pk_bf16_f32 v53, v74, v75
    v_exp_f32 v77, v77
    v_exp_f32 v78, v78
    v_exp_f32 v79, v79
    v_smfmac_f32_16x16x64_bf16 v[12:15], v[8:11], v[56:63], v5
    buffer_load_dwordx4 v1, s[28:31], s81 offen sc1 lds
    s_waitcnt lgkmcnt(0)
    v_cvt_pk_bf16_f32 v54, v76, v77
    v_cvt_pk_bf16_f32 v55, v78, v79
    v_mfma_f32_32x32x16_bf16 v[64:79], v[32:35], v[24:27], 0
    ds_read_b128 v[32:35], v3 offset:20480
    v_exp_f32 v80, v80
    v_exp_f32 v81, v81
    v_exp_f32 v82, v82
    v_exp_f32 v83, v83
    v_mfma_f32_32x32x16_bf16 v[96:111], v[40:43], v[48:51], v[96:111]
    ds_read_b128 v[40:43], v3 offset:14336
    s_add_u32 m0, s75, 16384
    v_cvt_pk_bf16_f32 v56, v80, v81
    v_cvt_pk_bf16_f32 v57, v82, v83
    v_exp_f32 v84, v84
    v_exp_f32 v85, v85
    v_exp_f32 v86, v86
    v_mfma_f32_32x32x16_bf16 v[64:79], v[36:39], v[28:31], v[64:79]
    ds_read_b128 v[36:39], v3 offset:21504
    buffer_load_dwordx4 v1, s[28:31], s82 offen sc1 lds
    v_exp_f32 v87, v87
    v_cvt_pk_bf16_f32 v58, v84, v85
    v_exp_f32 v88, v88
    v_cvt_pk_bf16_f32 v59, v86, v87
    v_mfma_f32_32x32x16_bf16 v[96:111], v[44:47], v[52:55], v[96:111]
    ds_read_b128 v[44:47], v3 offset:15360
    s_add_u32 m0, s75, 24576
    v_exp_f32 v89, v89
    v_exp_f32 v90, v90
    v_cvt_pk_bf16_f32 v60, v88, v89
    v_exp_f32 v91, v91
    v_exp_f32 v92, v92
    v_cvt_pk_bf16_f32 v61, v90, v91
    v_exp_f32 v93, v93
    v_exp_f32 v94, v94
    v_exp_f32 v95, v95
    v_smfmac_f32_16x16x64_bf16 v[12:15], v[8:11], v[48:55], v5
    buffer_load_dwordx4 v1, s[28:31], s83 offen sc1 lds
    s_waitcnt lgkmcnt(0)
    v_cvt_pk_bf16_f32 v62, v92, v93
    v_cvt_pk_bf16_f32 v63, v94, v95
    v_mfma_f32_32x32x16_bf16 v[80:95], v[32:35], v[24:27], 0
    ds_read_b128 v[32:35], v3 offset:24576
    v_exp_f32 v64, v64
    v_exp_f32 v65, v65
    v_exp_f32 v66, v66
    v_exp_f32 v67, v67
    v_mfma_f32_32x32x16_bf16 v[96:111], v[40:43], v[56:59], v[96:111]
    ds_read_b128 v[40:43], v3 offset:18432
    s_add_u32 m0, s75, 32768
    v_cvt_pk_bf16_f32 v48, v64, v65
    v_cvt_pk_bf16_f32 v49, v66, v67
    v_exp_f32 v68, v68
    v_exp_f32 v69, v69
    v_exp_f32 v70, v70
    v_mfma_f32_32x32x16_bf16 v[80:95], v[36:39], v[28:31], v[80:95]
    ds_read_b128 v[36:39], v3 offset:25600
    buffer_load_dwordx4 v1, s[28:31], s84 offen sc1 lds
    v_exp_f32 v71, v71
    v_cvt_pk_bf16_f32 v50, v68, v69
    v_exp_f32 v72, v72
    v_cvt_pk_bf16_f32 v51, v70, v71
    v_mfma_f32_32x32x16_bf16 v[96:111], v[44:47], v[60:63], v[96:111]
    ds_read_b128 v[44:47], v3 offset:19456
    s_add_u32 m0, s75, 40960
    v_exp_f32 v73, v73
    v_exp_f32 v74, v74
    v_cvt_pk_bf16_f32 v52, v72, v73
    v_exp_f32 v75, v75
    v_exp_f32 v76, v76
    v_cvt_pk_bf16_f32 v53, v74, v75
    v_exp_f32 v77, v77
    v_exp_f32 v78, v78
    v_exp_f32 v79, v79
    v_smfmac_f32_16x16x64_bf16 v[12:15], v[8:11], v[56:63], v5
    buffer_load_dwordx4 v1, s[28:31], s85 offen sc1 lds
    s_waitcnt lgkmcnt(0)
    v_cvt_pk_bf16_f32 v54, v76, v77
    v_cvt_pk_bf16_f32 v55, v78, v79
    v_mfma_f32_32x32x16_bf16 v[64:79], v[32:35], v[24:27], 0
    ds_read_b128 v[32:35], v3 offset:28672
    v_exp_f32 v80, v80
    v_exp_f32 v81, v81
    v_exp_f32 v82, v82
    v_exp_f32 v83, v83
    v_mfma_f32_32x32x16_bf16 v[96:111], v[40:43], v[48:51], v[96:111]
    ds_read_b128 v[40:43], v3 offset:22528
    s_add_u32 m0, s75, 49152
    v_cvt_pk_bf16_f32 v56, v80, v81
    v_cvt_pk_bf16_f32 v57, v82, v83
    v_exp_f32 v84, v84
    v_exp_f32 v85, v85
    v_exp_f32 v86, v86
    v_mfma_f32_32x32x16_bf16 v[64:79], v[36:39], v[28:31], v[64:79]
    ds_read_b128 v[36:39], v3 offset:29696
    buffer_load_dwordx4 v191, s[28:31], s80 offen sc1 lds
    v_exp_f32 v87, v87
    v_cvt_pk_bf16_f32 v58, v84, v85
    v_exp_f32 v88, v88
    v_cvt_pk_bf16_f32 v59, v86, v87
    v_mfma_f32_32x32x16_bf16 v[96:111], v[44:47], v[52:55], v[96:111]
    ds_read_b128 v[44:47], v3 offset:23552
    s_add_u32 m0, s75, 57344
    v_exp_f32 v89, v89
    v_exp_f32 v90, v90
    v_cvt_pk_bf16_f32 v60, v88, v89
    v_exp_f32 v91, v91
    v_exp_f32 v92, v92
    v_cvt_pk_bf16_f32 v61, v90, v91
    v_exp_f32 v93, v93
    v_exp_f32 v94, v94
    v_exp_f32 v95, v95
    v_smfmac_f32_16x16x64_bf16 v[12:15], v[8:11], v[48:55], v5
    buffer_load_dwordx4 v191, s[28:31], s81 offen sc1 lds
    s_waitcnt lgkmcnt(0)
    v_cvt_pk_bf16_f32 v62, v92, v93
    v_cvt_pk_bf16_f32 v63, v94, v95
    s_setprio 2
    v_mfma_f32_32x32x16_bf16 v[80:95], v[32:35], v[24:27], 0
    ds_read_b128 v[32:35], v2 offset:32768
    v_exp_f32 v64, v64
    v_exp_f32 v65, v65
    v_exp_f32 v66, v66
    v_exp_f32 v67, v67
    v_mfma_f32_32x32x16_bf16 v[96:111], v[40:43], v[56:59], v[96:111]
    ds_read_b128 v[40:43], v3 offset:26624
    s_add_u32 m0, s75, 65536
    v_cvt_pk_bf16_f32 v48, v64, v65
    v_cvt_pk_bf16_f32 v49, v66, v67
    v_exp_f32 v68, v68
    v_exp_f32 v69, v69
    v_exp_f32 v70, v70
    v_mfma_f32_32x32x16_bf16 v[80:95], v[36:39], v[28:31], v[80:95]
    ds_read_b128 v[36:39], v2 offset:33792
    buffer_load_dwordx4 v191, s[28:31], s82 offen sc1 lds
    v_exp_f32 v71, v71
    v_cvt_pk_bf16_f32 v50, v68, v69
    v_exp_f32 v72, v72
    v_cvt_pk_bf16_f32 v51, v70, v71
    v_mfma_f32_32x32x16_bf16 v[96:111], v[44:47], v[60:63], v[96:111]
    ds_read_b128 v[44:47], v3 offset:27648
    s_add_u32 m0, s75, 73728
    v_exp_f32 v73, v73
    v_exp_f32 v74, v74
    v_cvt_pk_bf16_f32 v52, v72, v73
    v_exp_f32 v75, v75
    v_exp_f32 v76, v76
    v_cvt_pk_bf16_f32 v53, v74, v75
    v_exp_f32 v77, v77
    v_exp_f32 v78, v78
    v_exp_f32 v79, v79
    v_smfmac_f32_16x16x64_bf16 v[12:15], v[8:11], v[56:63], v5
    buffer_load_dwordx4 v191, s[28:31], s83 offen sc1 lds
    s_waitcnt lgkmcnt(0)
    v_cvt_pk_bf16_f32 v54, v76, v77
    v_cvt_pk_bf16_f32 v55, v78, v79
    v_mfma_f32_32x32x16_bf16 v[64:79], v[32:35], v[24:27], 0
    ds_read_b128 v[32:35], v2 offset:36864
    v_exp_f32 v80, v80
    v_exp_f32 v81, v81
    v_exp_f32 v82, v82
    v_exp_f32 v83, v83
    v_mfma_f32_32x32x16_bf16 v[96:111], v[40:43], v[48:51], v[96:111]
    ds_read_b128 v[40:43], v3 offset:30720
    s_add_u32 m0, s75, 81920
    v_cvt_pk_bf16_f32 v56, v80, v81
    v_cvt_pk_bf16_f32 v57, v82, v83
    v_exp_f32 v84, v84
    v_exp_f32 v85, v85
    v_exp_f32 v86, v86
    v_mfma_f32_32x32x16_bf16 v[64:79], v[36:39], v[28:31], v[64:79]
    ds_read_b128 v[36:39], v2 offset:37888
    buffer_load_dwordx4 v191, s[28:31], s84 offen sc1 lds
    v_exp_f32 v87, v87
    v_cvt_pk_bf16_f32 v58, v84, v85
    v_exp_f32 v88, v88
    v_cvt_pk_bf16_f32 v59, v86, v87
    v_mfma_f32_32x32x16_bf16 v[96:111], v[44:47], v[52:55], v[96:111]
    ds_read_b128 v[44:47], v3 offset:31744
    s_add_u32 m0, s75, 90112
    v_exp_f32 v89, v89
    v_exp_f32 v90, v90
    v_cvt_pk_bf16_f32 v60, v88, v89
    v_and_b32 v189, 31, v0
    v_lshlrev_b32 v189, 2, v189
    v_exp_f32 v91, v91
    v_exp_f32 v92, v92
    v_cvt_pk_bf16_f32 v61, v90, v91
    v_exp_f32 v93, v93
    v_exp_f32 v94, v94
    v_exp_f32 v95, v95
    v_smfmac_f32_16x16x64_bf16 v[12:15], v[8:11], v[48:55], v5
    buffer_load_dwordx4 v191, s[28:31], s85 offen sc1 lds
    s_waitcnt lgkmcnt(0)
    v_cvt_pk_bf16_f32 v62, v92, v93
    v_cvt_pk_bf16_f32 v63, v94, v95
    v_mfma_f32_32x32x16_bf16 v[80:95], v[32:35], v[24:27], 0
    ds_read_b128 v[32:35], v2 offset:40960
    v_exp_f32 v64, v64
    v_exp_f32 v65, v65
    v_exp_f32 v66, v66
    v_exp_f32 v67, v67
    v_mfma_f32_32x32x16_bf16 v[96:111], v[40:43], v[56:59], v[96:111]
    ds_read_b128 v[40:43], v2 offset:34816
    v_cvt_pk_bf16_f32 v48, v64, v65
    v_cvt_pk_bf16_f32 v49, v66, v67
    v_exp_f32 v68, v68
    v_exp_f32 v69, v69
    v_exp_f32 v70, v70
    v_mfma_f32_32x32x16_bf16 v[80:95], v[36:39], v[28:31], v[80:95]
    ds_read_b128 v[36:39], v2 offset:41984
    v_exp_f32 v71, v71
    v_cvt_pk_bf16_f32 v50, v68, v69
    v_exp_f32 v72, v72
    v_cvt_pk_bf16_f32 v51, v70, v71
    v_mfma_f32_32x32x16_bf16 v[96:111], v[44:47], v[60:63], v[96:111]
    ds_read_b128 v[44:47], v2 offset:35840
    v_exp_f32 v73, v73
    v_exp_f32 v74, v74
    v_cvt_pk_bf16_f32 v52, v72, v73
    v_lshrrev_b32 v192, 3, v0
    v_bfe_u32 v180, v0, 4, 2
    v_lshlrev_b32 v180, 1, v180
    v_and_b32 v181, 7, v0
    v_xor_b32 v180, v180, v181
    v_lshlrev_b32 v180, 4, v180
    v_lshl_add_u32 v192, v192, 11, v180
    v_exp_f32 v75, v75
    v_exp_f32 v76, v76
    v_cvt_pk_bf16_f32 v53, v74, v75
    v_exp_f32 v77, v77
    v_exp_f32 v78, v78
    v_exp_f32 v79, v79
    v_smfmac_f32_16x16x64_bf16 v[12:15], v[8:11], v[56:63], v5
    buffer_load_dword v4, v189, s[28:31], s78 offen sc1
    s_waitcnt lgkmcnt(0)
    v_cvt_pk_bf16_f32 v54, v76, v77
    v_cvt_pk_bf16_f32 v55, v78, v79
    v_mfma_f32_32x32x16_bf16 v[64:79], v[32:35], v[24:27], 0
    ds_read_b128 v[32:35], v2 offset:45056
    v_exp_f32 v80, v80
    v_exp_f32 v81, v81
    v_exp_f32 v82, v82
    v_exp_f32 v83, v83
    v_mfma_f32_32x32x16_bf16 v[96:111], v[40:43], v[48:51], v[96:111]
    ds_read_b128 v[40:43], v2 offset:38912
    v_cvt_pk_bf16_f32 v56, v80, v81
    v_cvt_pk_bf16_f32 v57, v82, v83
    v_exp_f32 v84, v84
    v_exp_f32 v85, v85
    v_exp_f32 v86, v86
    v_mfma_f32_32x32x16_bf16 v[64:79], v[36:39], v[28:31], v[64:79]
    ds_read_b128 v[36:39], v2 offset:46080
    v_exp_f32 v87, v87
    v_cvt_pk_bf16_f32 v58, v84, v85
    v_exp_f32 v88, v88
    v_cvt_pk_bf16_f32 v59, v86, v87
    v_mfma_f32_32x32x16_bf16 v[96:111], v[44:47], v[52:55], v[96:111]
    ds_read_b128 v[44:47], v2 offset:39936
    v_exp_f32 v89, v89
    v_exp_f32 v90, v90
    v_cvt_pk_bf16_f32 v60, v88, v89
    v_add_u32 v193, 15360, v192
    v_add_u32 v194, 30720, v192
    v_add_u32 v195, 46080, v192
    v_exp_f32 v91, v91
    v_exp_f32 v92, v92
    v_cvt_pk_bf16_f32 v61, v90, v91
    v_exp_f32 v93, v93
    v_exp_f32 v94, v94
    v_exp_f32 v95, v95
    v_smfmac_f32_16x16x64_bf16 v[12:15], v[8:11], v[48:55], v5
    s_waitcnt lgkmcnt(0)
    v_cvt_pk_bf16_f32 v62, v92, v93
    v_cvt_pk_bf16_f32 v63, v94, v95
    s_waitcnt vmcnt(1)
    s_barrier
    s_setprio 3
    v_mfma_f32_32x32x16_bf16 v[80:95], v[32:35], v[24:27], 0
    ds_read_b128 v[32:35], v188 offset:0
    v_exp_f32 v64, v64
    v_exp_f32 v65, v65
    v_exp_f32 v66, v66
    v_exp_f32 v67, v67
    v_mfma_f32_32x32x16_bf16 v[96:111], v[40:43], v[56:59], v[96:111]
    ds_read_b128 v[40:43], v2 offset:43008
    s_add_u32 m0, s74, 131072
    v_cvt_pk_bf16_f32 v48, v64, v65
    v_cvt_pk_bf16_f32 v49, v66, v67
    v_exp_f32 v68, v68
    v_exp_f32 v69, v69
    v_exp_f32 v70, v70
    v_mfma_f32_32x32x16_bf16 v[80:95], v[36:39], v[28:31], v[80:95]
    ds_read_b128 v[36:39], v188 offset:1024
    s_add_u32 s26, s74, 16908288
    v_exp_f32 v71, v71
    v_cvt_pk_bf16_f32 v50, v68, v69
    v_exp_f32 v72, v72
    v_cvt_pk_bf16_f32 v51, v70, v71
    v_mfma_f32_32x32x16_bf16 v[96:111], v[44:47], v[60:63], v[96:111]
    ds_read_b128 v[44:47], v2 offset:44032
    buffer_load_dwordx4 v1, s[28:31], s26 offen offset:0 sc1 lds
    v_exp_f32 v73, v73
    v_exp_f32 v74, v74
    v_cvt_pk_bf16_f32 v52, v72, v73
    v_exp_f32 v75, v75
    v_exp_f32 v76, v76
    v_cvt_pk_bf16_f32 v53, v74, v75
    v_exp_f32 v77, v77
    v_exp_f32 v78, v78
    v_exp_f32 v79, v79
    v_smfmac_f32_16x16x64_bf16 v[12:15], v[8:11], v[56:63], v5
    buffer_load_dwordx4 v1, s[28:31], s26 offen offset:1024 sc1 lds
    s_waitcnt lgkmcnt(0)
    v_cvt_pk_bf16_f32 v54, v76, v77
    v_cvt_pk_bf16_f32 v55, v78, v79
    v_mfma_f32_32x32x16_bf16 v[64:79], v[32:35], v[16:19], v[148:163]
    ds_read_b128 v[32:35], v188 offset:4096
    v_exp_f32 v80, v80
    v_exp_f32 v81, v81
    v_exp_f32 v82, v82
    v_exp_f32 v83, v83
    v_mfma_f32_32x32x16_bf16 v[96:111], v[40:43], v[48:51], v[96:111]
    ds_read_b128 v[40:43], v2 offset:47104
    v_cvt_pk_bf16_f32 v56, v80, v81
    v_cvt_pk_bf16_f32 v57, v82, v83
    v_exp_f32 v84, v84
    v_exp_f32 v85, v85
    v_exp_f32 v86, v86
    v_mfma_f32_32x32x16_bf16 v[64:79], v[36:39], v[20:23], v[64:79]
    ds_read_b128 v[36:39], v188 offset:5120
    v_exp_f32 v87, v87
    v_cvt_pk_bf16_f32 v58, v84, v85
    v_exp_f32 v88, v88
    v_cvt_pk_bf16_f32 v59, v86, v87
    v_mfma_f32_32x32x16_bf16 v[96:111], v[44:47], v[52:55], v[96:111]
    ds_read_b128 v[44:47], v2 offset:48128
    buffer_load_dwordx4 v1, s[28:31], s26 offen offset:2048 sc1 lds
    v_exp_f32 v89, v89
    v_exp_f32 v90, v90
    v_cvt_pk_bf16_f32 v60, v88, v89
    v_exp_f32 v91, v91
    v_exp_f32 v92, v92
    v_cvt_pk_bf16_f32 v61, v90, v91
    v_exp_f32 v93, v93
    v_exp_f32 v94, v94
    v_exp_f32 v95, v95
    v_smfmac_f32_16x16x64_bf16 v[12:15], v[8:11], v[48:55], v5
    buffer_load_dwordx4 v1, s[28:31], s26 offen offset:3072 sc1 lds
    s_waitcnt lgkmcnt(0)
    v_cvt_pk_bf16_f32 v62, v92, v93
    v_cvt_pk_bf16_f32 v63, v94, v95
    v_mfma_f32_32x32x16_bf16 v[80:95], v[32:35], v[16:19], v[164:179]
    ds_read_b128 v[32:35], v188 offset:8192
    v_exp_f32 v64, v64
    v_exp_f32 v65, v65
    v_exp_f32 v66, v66
    v_exp_f32 v67, v67
    v_mfma_f32_32x32x16_bf16 v[96:111], v[40:43], v[56:59], v[96:111]
    ds_read_b128 v[40:43], v188 offset:2048
    v_cvt_pk_bf16_f32 v48, v64, v65
    v_cvt_pk_bf16_f32 v49, v66, v67
    v_exp_f32 v68, v68
    v_exp_f32 v69, v69
    v_exp_f32 v70, v70
    v_mfma_f32_32x32x16_bf16 v[80:95], v[36:39], v[20:23], v[80:95]
    ds_read_b128 v[36:39], v188 offset:9216
    v_exp_f32 v71, v71
    v_cvt_pk_bf16_f32 v50, v68, v69
    v_exp_f32 v72, v72
    v_cvt_pk_bf16_f32 v51, v70, v71
    v_mfma_f32_32x32x16_bf16 v[96:111], v[44:47], v[60:63], v[96:111]
    ds_read_b128 v[44:47], v188 offset:3072
    v_exp_f32 v73, v73
    v_exp_f32 v74, v74
    v_cvt_pk_bf16_f32 v52, v72, v73
    v_exp_f32 v75, v75
    v_exp_f32 v76, v76
    v_cvt_pk_bf16_f32 v53, v74, v75
    v_exp_f32 v77, v77
    v_exp_f32 v78, v78
    v_exp_f32 v79, v79
    v_smfmac_f32_16x16x64_bf16 v[12:15], v[8:11], v[56:63], v5
    buffer_load_dwordx4 v[252:255], v192, s[40:43], s77 offen offset:0
    s_waitcnt lgkmcnt(0)
    v_cvt_pk_bf16_f32 v54, v76, v77
    v_cvt_pk_bf16_f32 v55, v78, v79
    s_cmp_eq_u32 s76, 2
    s_cbranch_scc1 f_cm2
f_cm2_r:
    v_mfma_f32_32x32x16_bf16 v[64:79], v[32:35], v[16:19], v[164:179]
    ds_read_b128 v[32:35], v188 offset:12288
    v_exp_f32 v80, v80
    v_exp_f32 v81, v81
    v_exp_f32 v82, v82
    v_exp_f32 v83, v83
    v_mfma_f32_32x32x16_bf16 v[128:143], v[40:43], v[48:51], 0
    ds_read_b128 v[40:43], v188 offset:6144
    v_cvt_pk_bf16_f32 v56, v80, v81
    v_cvt_pk_bf16_f32 v57, v82, v83
    v_exp_f32 v84, v84
    v_exp_f32 v85, v85
    v_exp_f32 v86, v86
    v_mfma_f32_32x32x16_bf16 v[64:79], v[36:39], v[20:23], v[64:79]
    ds_read_b128 v[36:39], v188 offset:13312
    v_exp_f32 v87, v87
    v_cvt_pk_bf16_f32 v58, v84, v85
    v_exp_f32 v88, v88
    v_cvt_pk_bf16_f32 v59, v86, v87
    v_mfma_f32_32x32x16_bf16 v[128:143], v[44:47], v[52:55], v[128:143]
    ds_read_b128 v[44:47], v188 offset:7168
    v_exp_f32 v89, v89
    v_exp_f32 v90, v90
    v_cvt_pk_bf16_f32 v60, v88, v89
    v_exp_f32 v91, v91
    v_exp_f32 v92, v92
    v_cvt_pk_bf16_f32 v61, v90, v91
    v_exp_f32 v93, v93
    v_exp_f32 v94, v94
    v_exp_f32 v95, v95
    v_smfmac_f32_16x16x64_bf16 v[144:147], v[8:11], v[48:55], v5
    buffer_load_dwordx4 v[252:255], v193, s[40:43], s77 offen offset:1024
    s_waitcnt lgkmcnt(0)
    v_cvt_pk_bf16_f32 v62, v92, v93
    v_cvt_pk_bf16_f32 v63, v94, v95
    s_cmp_eq_u32 s76, 3
    s_cbranch_scc1 f_cm3
f_cm3_r:
    v_mfma_f32_32x32x16_bf16 v[80:95], v[32:35], v[16:19], v[164:179]
    ds_read_b128 v[32:35], v188 offset:16384
    v_exp_f32 v64, v64
    v_exp_f32 v65, v65
    v_exp_f32 v66, v66
    v_exp_f32 v67, v67
    v_mfma_f32_32x32x16_bf16 v[128:143], v[40:43], v[56:59], v[128:143]
    ds_read_b128 v[40:43], v188 offset:10240
    v_cvt_pk_bf16_f32 v48, v64, v65
    v_cvt_pk_bf16_f32 v49, v66, v67
    v_exp_f32 v68, v68
    v_exp_f32 v69, v69
    v_exp_f32 v70, v70
    v_mfma_f32_32x32x16_bf16 v[80:95], v[36:39], v[20:23], v[80:95]
    ds_read_b128 v[36:39], v188 offset:17408
    v_exp_f32 v71, v71
    v_cvt_pk_bf16_f32 v50, v68, v69
    v_exp_f32 v72, v72
    v_cvt_pk_bf16_f32 v51, v70, v71
    v_mfma_f32_32x32x16_bf16 v[128:143], v[44:47], v[60:63], v[128:143]
    ds_read_b128 v[44:47], v188 offset:11264
    v_exp_f32 v73, v73
    v_exp_f32 v74, v74
    v_cvt_pk_bf16_f32 v52, v72, v73
    v_exp_f32 v75, v75
    v_exp_f32 v76, v76
    v_cvt_pk_bf16_f32 v53, v74, v75
    v_exp_f32 v77, v77
    v_exp_f32 v78, v78
    v_exp_f32 v79, v79
    v_smfmac_f32_16x16x64_bf16 v[144:147], v[8:11], v[56:63], v5
    buffer_load_dwordx4 v[252:255], v194, s[40:43], s77 offen offset:2048
    s_waitcnt lgkmcnt(0)
    v_cvt_pk_bf16_f32 v54, v76, v77
    v_cvt_pk_bf16_f32 v55, v78, v79
    s_cmp_eq_u32 s76, 4
    s_cbranch_scc1 f_cm4
f_cm4_r:
    v_mfma_f32_32x32x16_bf16 v[64:79], v[32:35], v[16:19], v[164:179]
    ds_read_b128 v[32:35], v188 offset:20480
    v_exp_f32 v80, v80
    v_exp_f32 v81, v81
    v_exp_f32 v82, v82
    v_exp_f32 v83, v83
    v_mfma_f32_32x32x16_bf16 v[128:143], v[40:43], v[48:51], v[128:143]
    ds_read_b128 v[40:43], v188 offset:14336
    v_cvt_pk_bf16_f32 v56, v80, v81
    v_cvt_pk_bf16_f32 v57, v82, v83
    v_exp_f32 v84, v84
    v_exp_f32 v85, v85
    v_exp_f32 v86, v86
    v_mfma_f32_32x32x16_bf16 v[64:79], v[36:39], v[20:23], v[64:79]
    ds_read_b128 v[36:39], v188 offset:21504
    v_exp_f32 v87, v87
    v_cvt_pk_bf16_f32 v58, v84, v85
    v_exp_f32 v88, v88
    v_cvt_pk_bf16_f32 v59, v86, v87
    v_mfma_f32_32x32x16_bf16 v[128:143], v[44:47], v[52:55], v[128:143]
    ds_read_b128 v[44:47], v188 offset:15360
    v_exp_f32 v89, v89
    v_exp_f32 v90, v90
    v_cvt_pk_bf16_f32 v60, v88, v89
    v_exp_f32 v91, v91
    v_exp_f32 v92, v92
    v_cvt_pk_bf16_f32 v61, v90, v91
    v_exp_f32 v93, v93
    v_exp_f32 v94, v94
    v_exp_f32 v95, v95
    v_smfmac_f32_16x16x64_bf16 v[144:147], v[8:11], v[48:55], v5
    buffer_load_dwordx4 v[252:255], v195, s[40:43], s77 offen offset:3072
    s_waitcnt lgkmcnt(0)
    v_cvt_pk_bf16_f32 v62, v92, v93
    v_cvt_pk_bf16_f32 v63, v94, v95
    s_cmp_eq_u32 s76, 5
    s_cbranch_scc1 f_cm5
f_cm5_r:
    v_mfma_f32_32x32x16_bf16 v[80:95], v[32:35], v[16:19], v[164:179]
    ds_read_b128 v[32:35], v188 offset:24576
    v_exp_f32 v64, v64
    v_exp_f32 v65, v65
    v_exp_f32 v66, v66
    v_exp_f32 v67, v67
    v_mfma_f32_32x32x16_bf16 v[128:143], v[40:43], v[56:59], v[128:143]
    ds_read_b128 v[40:43], v188 offset:18432
    v_cvt_pk_bf16_f32 v48, v64, v65
    v_cvt_pk_bf16_f32 v49, v66, v67
    v_exp_f32 v68, v68
    v_exp_f32 v69, v69
    v_exp_f32 v70, v70
    v_mfma_f32_32x32x16_bf16 v[80:95], v[36:39], v[20:23], v[80:95]
    ds_read_b128 v[36:39], v188 offset:25600
    v_exp_f32 v71, v71
    v_cvt_pk_bf16_f32 v50, v68, v69
    v_exp_f32 v72, v72
    v_cvt_pk_bf16_f32 v51, v70, v71
    v_mfma_f32_32x32x16_bf16 v[128:143], v[44:47], v[60:63], v[128:143]
    ds_read_b128 v[44:47], v188 offset:19456
    v_exp_f32 v73, v73
    v_exp_f32 v74, v74
    v_cvt_pk_bf16_f32 v52, v72, v73
    v_exp_f32 v75, v75
    v_exp_f32 v76, v76
    v_cvt_pk_bf16_f32 v53, v74, v75
    v_exp_f32 v77, v77
    v_exp_f32 v78, v78
    v_exp_f32 v79, v79
    v_smfmac_f32_16x16x64_bf16 v[144:147], v[8:11], v[56:63], v5
    buffer_load_dwordx4 v[252:255], v192, s[36:39], s77 offen offset:0
    s_waitcnt lgkmcnt(0)
    v_cvt_pk_bf16_f32 v54, v76, v77
    v_cvt_pk_bf16_f32 v55, v78, v79
    s_setprio 2
    s_cmp_eq_u32 s76, 6
    s_cbranch_scc1 f_cm6
f_cm6_r:
    v_mfma_f32_32x32x16_bf16 v[64:79], v[32:35], v[16:19], v[164:179]
    ds_read_b128 v[32:35], v188 offset:28672
    v_exp_f32 v80, v80
    v_exp_f32 v81, v81
    v_exp_f32 v82, v82
    v_exp_f32 v83, v83
    v_mfma_f32_32x32x16_bf16 v[128:143], v[40:43], v[48:51], v[128:143]
    ds_read_b128 v[40:43], v188 offset:22528
    v_cvt_pk_bf16_f32 v56, v80, v81
    v_cvt_pk_bf16_f32 v57, v82, v83
    v_exp_f32 v84, v84
    v_exp_f32 v85, v85
    v_exp_f32 v86, v86
    v_mfma_f32_32x32x16_bf16 v[64:79], v[36:39], v[20:23], v[64:79]
    ds_read_b128 v[36:39], v188 offset:29696
    v_exp_f32 v87, v87
    v_cvt_pk_bf16_f32 v58, v84, v85
    v_exp_f32 v88, v88
    v_cvt_pk_bf16_f32 v59, v86, v87
    v_mfma_f32_32x32x16_bf16 v[128:143], v[44:47], v[52:55], v[128:143]
    ds_read_b128 v[44:47], v188 offset:23552
    v_exp_f32 v89, v89
    v_exp_f32 v90, v90
    v_cvt_pk_bf16_f32 v60, v88, v89
    v_exp_f32 v91, v91
    v_exp_f32 v92, v92
    v_cvt_pk_bf16_f32 v61, v90, v91
    v_exp_f32 v93, v93
    v_exp_f32 v94, v94
    v_exp_f32 v95, v95
    v_smfmac_f32_16x16x64_bf16 v[144:147], v[8:11], v[48:55], v5
    buffer_load_dwordx4 v[252:255], v193, s[36:39], s77 offen offset:1024
    s_waitcnt lgkmcnt(0)
    v_cvt_pk_bf16_f32 v62, v92, v93
    v_cvt_pk_bf16_f32 v63, v94, v95
    s_cmp_eq_u32 s76, 7
    s_cbranch_scc1 f_cm7
f_cm7_r:
    v_mfma_f32_32x32x16_bf16 v[80:95], v[32:35], v[16:19], v[164:179]
    ds_read_b128 v[32:35], v188 offset:32768
    v_exp_f32 v64, v64
    v_exp_f32 v65, v65
    v_exp_f32 v66, v66
    v_exp_f32 v67, v67
    v_mfma_f32_32x32x16_bf16 v[128:143], v[40:43], v[56:59], v[128:143]
    ds_read_b128 v[40:43], v188 offset:26624
    v_cvt_pk_bf16_f32 v48, v64, v65
    v_cvt_pk_bf16_f32 v49, v66, v67
    v_exp_f32 v68, v68
    v_exp_f32 v69, v69
    v_exp_f32 v70, v70
    v_mfma_f32_32x32x16_bf16 v[80:95], v[36:39], v[20:23], v[80:95]
    ds_read_b128 v[36:39], v188 offset:33792
    v_exp_f32 v71, v71
    v_cvt_pk_bf16_f32 v50, v68, v69
    v_exp_f32 v72, v72
    v_cvt_pk_bf16_f32 v51, v70, v71
    v_mfma_f32_32x32x16_bf16 v[128:143], v[44:47], v[60:63], v[128:143]
    ds_read_b128 v[44:47], v188 offset:27648
    v_exp_f32 v73, v73
    v_exp_f32 v74, v74
    v_cvt_pk_bf16_f32 v52, v72, v73
    v_exp_f32 v75, v75
    v_exp_f32 v76, v76
    v_cvt_pk_bf16_f32 v53, v74, v75
    v_exp_f32 v77, v77
    v_exp_f32 v78, v78
    v_exp_f32 v79, v79
    v_smfmac_f32_16x16x64_bf16 v[144:147], v[8:11], v[56:63], v5
    buffer_load_dwordx4 v[252:255], v194, s[36:39], s77 offen offset:2048
    s_waitcnt lgkmcnt(0)
    v_cvt_pk_bf16_f32 v54, v76, v77
    v_cvt_pk_bf16_f32 v55, v78, v79
    v_mfma_f32_32x32x16_bf16 v[64:79], v[32:35], v[16:19], v[112:127]
    ds_read_b128 v[32:35], v2 offset:49152
    v_exp_f32 v80, v80
    v_exp_f32 v81, v81
    v_exp_f32 v82, v82
    v_exp_f32 v83, v83
    v_mfma_f32_32x32x16_bf16 v[128:143], v[40:43], v[48:51], v[128:143]
    ds_read_b128 v[40:43], v188 offset:30720
    v_cvt_pk_bf16_f32 v56, v80, v81
    v_cvt_pk_bf16_f32 v57, v82, v83
    v_exp_f32 v84, v84
    v_exp_f32 v85, v85
    v_exp_f32 v86, v86
    v_mfma_f32_32x32x16_bf16 v[64:79], v[36:39], v[20:23], v[64:79]
    ds_read_b128 v[36:39], v2 offset:50176
    v_exp_f32 v87, v87
    v_cvt_pk_bf16_f32 v58, v84, v85
    v_exp_f32 v88, v88
    v_cvt_pk_bf16_f32 v59, v86, v87
    v_mfma_f32_32x32x16_bf16 v[128:143], v[44:47], v[52:55], v[128:143]
    ds_read_b128 v[44:47], v188 offset:31744
    v_exp_f32 v89, v89
    v_exp_f32 v90, v90
    v_cvt_pk_bf16_f32 v60, v88, v89
    v_exp_f32 v91, v91
    v_exp_f32 v92, v92
    v_cvt_pk_bf16_f32 v61, v90, v91
    v_exp_f32 v93, v93
    v_exp_f32 v94, v94
    v_exp_f32 v95, v95
    v_smfmac_f32_16x16x64_bf16 v[144:147], v[8:11], v[48:55], v5
    buffer_load_dwordx4 v[252:255], v195, s[36:39], s77 offen offset:3072
    s_waitcnt lgkmcnt(0)
    v_cvt_pk_bf16_f32 v62, v92, v93
    v_cvt_pk_bf16_f32 v63, v94, v95
    v_mfma_f32_32x32x16_bf16 v[80:95], v[32:35], v[24:27], 0
    ds_read_b128 v[32:35], v2 offset:53248
    v_exp_f32 v64, v64
    v_exp_f32 v65, v65
    v_exp_f32 v66, v66
    v_exp_f32 v67, v67
    v_mfma_f32_32x32x16_bf16 v[128:143], v[40:43], v[56:59], v[128:143]
    ds_read_b128 v[40:43], v188 offset:34816
    v_cvt_pk_bf16_f32 v48, v64, v65
    v_cvt_pk_bf16_f32 v49, v66, v67
    v_exp_f32 v68, v68
    v_exp_f32 v69, v69
    v_exp_f32 v70, v70
    v_mfma_f32_32x32x16_bf16 v[80:95], v[36:39], v[28:31], v[80:95]
    ds_read_b128 v[36:39], v2 offset:54272
    v_exp_f32 v71, v71
    v_cvt_pk_bf16_f32 v50, v68, v69
    v_exp_f32 v72, v72
    v_cvt_pk_bf16_f32 v51, v70, v71
    v_mfma_f32_32x32x16_bf16 v[128:143], v[44:47], v[60:63], v[128:143]
    ds_read_b128 v[44:47], v188 offset:35840
    v_exp_f32 v73, v73
    v_exp_f32 v74, v74
    v_cvt_pk_bf16_f32 v52, v72, v73
    v_and_b32 v112, 15, v0
    v_bfe_u32 v113, v0, 4, 1
    v_lshrrev_b32 v114, 5, v0
    v_lshlrev_b32 v126, 11, v112
    v_lshl_add_u32 v126, v113, 5, v126
    v_lshl_add_u32 v126, v114, 4, v126
    v_lshlrev_b32 v112, 4, v112
    v_lshl_add_u32 v112, v113, 10, v112
    v_lshl_add_u32 v112, v114, 8, v112
    v_exp_f32 v75, v75
    v_exp_f32 v76, v76
    v_cvt_pk_bf16_f32 v53, v74, v75
    v_exp_f32 v77, v77
    v_exp_f32 v78, v78
    v_exp_f32 v79, v79
    v_smfmac_f32_16x16x64_bf16 v[144:147], v[8:11], v[56:63], v5
    s_waitcnt lgkmcnt(0)
    v_cvt_pk_bf16_f32 v54, v76, v77
    v_cvt_pk_bf16_f32 v55, v78, v79
    v_mfma_f32_32x32x16_bf16 v[64:79], v[32:35], v[24:27], 0
    ds_read_b128 v[32:35], v2 offset:57344
    v_exp_f32 v80, v80
    v_exp_f32 v81, v81
    v_exp_f32 v82, v82
    v_exp_f32 v83, v83
    v_mfma_f32_32x32x16_bf16 v[128:143], v[40:43], v[48:51], v[128:143]
    ds_read_b128 v[40:43], v2 offset:51200
    v_cvt_pk_bf16_f32 v56, v80, v81
    v_cvt_pk_bf16_f32 v57, v82, v83
    v_exp_f32 v84, v84
    v_exp_f32 v85, v85
    v_exp_f32 v86, v86
    v_mfma_f32_32x32x16_bf16 v[64:79], v[36:39], v[28:31], v[64:79]
    ds_read_b128 v[36:39], v2 offset:58368
    v_exp_f32 v87, v87
    v_cvt_pk_bf16_f32 v58, v84, v85
    v_exp_f32 v88, v88
    v_cvt_pk_bf16_f32 v59, v86, v87
    v_mfma_f32_32x32x16_bf16 v[128:143], v[44:47], v[52:55], v[128:143]
    ds_read_b128 v[44:47], v2 offset:52224
    v_exp_f32 v89, v89
    v_exp_f32 v90, v90
    v_cvt_pk_bf16_f32 v60, v88, v89
    v_mov_b32 v116, v192
    v_mov_b32 v113, v193
    v_mov_b32 v114, v194
    v_mov_b32 v115, v195
    v_exp_f32 v91, v91
    v_exp_f32 v92, v92
    v_cvt_pk_bf16_f32 v61, v90, v91
    v_exp_f32 v93, v93
    v_exp_f32 v94, v94
    v_exp_f32 v95, v95
    v_smfmac_f32_16x16x64_bf16 v[144:147], v[8:11], v[48:55], v5
    s_waitcnt lgkmcnt(0)
    v_cvt_pk_bf16_f32 v62, v92, v93
    v_cvt_pk_bf16_f32 v63, v94, v95
    v_mfma_f32_32x32x16_bf16 v[80:95], v[32:35], v[24:27], 0
    ds_read_b128 v[32:35], v2 offset:61440
    v_exp_f32 v64, v64
    v_exp_f32 v65, v65
    v_exp_f32 v66, v66
    v_exp_f32 v67, v67
    v_mfma_f32_32x32x16_bf16 v[96:111], v[40:43], v[56:59], v[96:111]
    ds_read_b128 v[40:43], v2 offset:55296
    v_cvt_pk_bf16_f32 v48, v64, v65
    v_cvt_pk_bf16_f32 v49, v66, v67
    v_exp_f32 v68, v68
    v_exp_f32 v69, v69
    v_exp_f32 v70, v70
    v_mfma_f32_32x32x16_bf16 v[80:95], v[36:39], v[28:31], v[80:95]
    ds_read_b128 v[36:39], v2 offset:62464
    v_exp_f32 v71, v71
    v_cvt_pk_bf16_f32 v50, v68, v69
    v_exp_f32 v72, v72
    v_cvt_pk_bf16_f32 v51, v70, v71
    v_mfma_f32_32x32x16_bf16 v[96:111], v[44:47], v[60:63], v[96:111]
    ds_read_b128 v[44:47], v2 offset:56320
    v_exp_f32 v73, v73
    v_exp_f32 v74, v74
    v_cvt_pk_bf16_f32 v52, v72, v73
    v_exp_f32 v75, v75
    v_exp_f32 v76, v76
    v_cvt_pk_bf16_f32 v53, v74, v75
    v_exp_f32 v77, v77
    v_exp_f32 v78, v78
    v_exp_f32 v79, v79
    v_smfmac_f32_16x16x64_bf16 v[12:15], v[8:11], v[56:63], v5
    s_waitcnt lgkmcnt(0)
    v_cvt_pk_bf16_f32 v54, v76, v77
    v_cvt_pk_bf16_f32 v55, v78, v79
    s_mov_b32 s63, 0
f_normB:
    v_add_f32 v7, v144, v145
    v_rcp_f32 v180, v7
    s_waitcnt vmcnt(12)
    v_sub_f32 v181, 1.0, v4
    v_mul_f32 v180, v180, v181
    v_pk_mul_f32 v[128:129], v[128:129], v[180:181] op_sel_hi:[1,0]
    v_pk_mul_f32 v[130:131], v[130:131], v[180:181] op_sel_hi:[1,0]
    v_pk_mul_f32 v[132:133], v[132:133], v[180:181] op_sel_hi:[1,0]
    v_pk_mul_f32 v[134:135], v[134:135], v[180:181] op_sel_hi:[1,0]
    v_pk_mul_f32 v[136:137], v[136:137], v[180:181] op_sel_hi:[1,0]
    v_pk_mul_f32 v[138:139], v[138:139], v[180:181] op_sel_hi:[1,0]
    v_pk_mul_f32 v[140:141], v[140:141], v[180:181] op_sel_hi:[1,0]
    v_pk_mul_f32 v[142:143], v[142:143], v[180:181] op_sel_hi:[1,0]
    v_pk_add_f32 v[182:183], v[128:129], v[130:131]
    v_pk_add_f32 v[182:183], v[182:183], v[132:133]
    v_pk_add_f32 v[182:183], v[182:183], v[134:135]
    v_pk_add_f32 v[182:183], v[182:183], v[136:137]
    v_pk_add_f32 v[182:183], v[182:183], v[138:139]
    v_pk_add_f32 v[182:183], v[182:183], v[140:141]
    v_pk_add_f32 v[182:183], v[182:183], v[142:143]
    v_sub_f32 v182, v182, v182
    v_fma_f32 v182, v183, v182, v7
    v_cmp_le_f32 vcc, 528482304, v182
    s_mov_b64 s[56:57], vcc
    v_cmp_ge_f32 vcc, 1602224128, v182
    v_cvt_pk_bf16_f32 v180, v128, v129
    v_cvt_pk_bf16_f32 v181, v130, v131
    v_cvt_pk_bf16_f32 v182, v132, v133
    v_cvt_pk_bf16_f32 v183, v134, v135
    v_cvt_pk_bf16_f32 v184, v136, v137
    v_cvt_pk_bf16_f32 v185, v138, v139
    v_cvt_pk_bf16_f32 v186, v140, v141
    v_cvt_pk_bf16_f32 v187, v142, v143
    s_and_b64 vcc, vcc, s[56:57]
    s_cmp_eq_u64 vcc, -1
    s_cselect_b32 s62, 1, s63
    s_cmp_eq_u32 s62, 0
    s_cbranch_scc1 f_slowB
    buffer_store_dwordx4 v[180:183], v112, s[28:31], s24 offen sc1
    buffer_store_dwordx4 v[184:187], v112, s[28:31], s24 offen offset:512 sc1
    s_waitcnt vmcnt(10)
    s_barrier
    s_setprio 3
    v_mfma_f32_32x32x16_bf16 v[64:79], v[32:35], v[24:27], 0
    ds_read_b128 v[32:35], v3 offset:0
    s_add_u32 m0, s74, 0
    v_exp_f32 v80, v80
    v_exp_f32 v81, v81
    v_exp_f32 v82, v82
    v_exp_f32 v83, v83
    v_mfma_f32_32x32x16_bf16 v[96:111], v[40:43], v[48:51], v[96:111]
    ds_read_b128 v[40:43], v2 offset:59392
    s_add_u32 s26, s74, 16941056
    v_cvt_pk_bf16_f32 v56, v80, v81
    v_cvt_pk_bf16_f32 v57, v82, v83
    v_exp_f32 v84, v84
    v_exp_f32 v85, v85
    v_exp_f32 v86, v86
    v_mfma_f32_32x32x16_bf16 v[64:79], v[36:39], v[28:31], v[64:79]
    ds_read_b128 v[36:39], v3 offset:1024
    buffer_load_dwordx4 v1, s[28:31], s26 offen offset:0 sc1 lds
    v_exp_f32 v87, v87
    v_cvt_pk_bf16_f32 v58, v84, v85
    v_exp_f32 v88, v88
    v_cvt_pk_bf16_f32 v59, v86, v87
    v_mfma_f32_32x32x16_bf16 v[96:111], v[44:47], v[52:55], v[96:111]
    ds_read_b128 v[44:47], v2 offset:60416
    buffer_load_dwordx4 v1, s[28:31], s26 offen offset:1024 sc1 lds
    v_exp_f32 v89, v89
    v_exp_f32 v90, v90
    v_cvt_pk_bf16_f32 v60, v88, v89
    v_exp_f32 v91, v91
    v_exp_f32 v92, v92
    v_cvt_pk_bf16_f32 v61, v90, v91
    v_exp_f32 v93, v93
    v_exp_f32 v94, v94
    v_exp_f32 v95, v95
    v_smfmac_f32_16x16x64_bf16 v[12:15], v[8:11], v[48:55], v5
    buffer_load_dwordx4 v1, s[28:31], s26 offen offset:2048 sc1 lds
    s_waitcnt lgkmcnt(0)
    v_cvt_pk_bf16_f32 v62, v92, v93
    v_cvt_pk_bf16_f32 v63, v94, v95
    v_mfma_f32_32x32x16_bf16 v[80:95], v[32:35], v[24:27], 0
    ds_read_b128 v[32:35], v3 offset:4096
    buffer_load_dwordx4 v1, s[28:31], s26 offen offset:3072 sc1 lds
    v_exp_f32 v64, v64
    v_exp_f32 v65, v65
    v_exp_f32 v66, v66
    v_exp_f32 v67, v67
    v_mfma_f32_32x32x16_bf16 v[96:111], v[40:43], v[56:59], v[96:111]
    ds_read_b128 v[40:43], v2 offset:63488
    s_add_u32 m0, s74, 32768
    v_cvt_pk_bf16_f32 v48, v64, v65
    v_cvt_pk_bf16_f32 v49, v66, v67
    v_exp_f32 v68, v68
    v_exp_f32 v69, v69
    v_exp_f32 v70, v70
    v_mfma_f32_32x32x16_bf16 v[80:95], v[36:39], v[28:31], v[80:95]
    ds_read_b128 v[36:39], v3 offset:5120
    s_add_u32 s26, s74, 16973824
    v_exp_f32 v71, v71
    v_cvt_pk_bf16_f32 v50, v68, v69
    v_exp_f32 v72, v72
    v_cvt_pk_bf16_f32 v51, v70, v71
    v_mfma_f32_32x32x16_bf16 v[96:111], v[44:47], v[60:63], v[96:111]
    ds_read_b128 v[44:47], v2 offset:64512
    buffer_load_dwordx4 v1, s[28:31], s26 offen offset:0 sc1 lds
    v_exp_f32 v73, v73
    v_exp_f32 v74, v74
    v_cvt_pk_bf16_f32 v52, v72, v73
    v_exp_f32 v75, v75
    v_exp_f32 v76, v76
    v_cvt_pk_bf16_f32 v53, v74, v75
    v_exp_f32 v77, v77
    v_exp_f32 v78, v78
    v_exp_f32 v79, v79
    v_smfmac_f32_16x16x64_bf16 v[12:15], v[8:11], v[56:63], v5
    buffer_load_dwordx4 v1, s[28:31], s26 offen offset:1024 sc1 lds
    s_waitcnt lgkmcnt(0)
    v_cvt_pk_bf16_f32 v54, v76, v77
    v_cvt_pk_bf16_f32 v55, v78, v79
    v_mfma_f32_32x32x16_bf16 v[64:79], v[32:35], v[24:27], 0
    ds_read_b128 v[32:35], v3 offset:8192
    buffer_load_dwordx4 v1, s[28:31], s26 offen offset:2048 sc1 lds
    v_exp_f32 v80, v80
    v_exp_f32 v81, v81
    v_exp_f32 v82, v82
    v_exp_f32 v83, v83
    v_mfma_f32_32x32x16_bf16 v[96:111], v[40:43], v[48:51], v[96:111]
    ds_read_b128 v[40:43], v3 offset:2048
    buffer_load_dwordx4 v1, s[28:31], s26 offen offset:3072 sc1 lds
    v_cvt_pk_bf16_f32 v56, v80, v81
    v_cvt_pk_bf16_f32 v57, v82, v83
    v_exp_f32 v84, v84
    v_exp_f32 v85, v85
    v_exp_f32 v86, v86
    v_mfma_f32_32x32x16_bf16 v[64:79], v[36:39], v[28:31], v[64:79]
    ds_read_b128 v[36:39], v3 offset:9216
    s_add_u32 m0, s74, 65536
    v_exp_f32 v87, v87
    v_cvt_pk_bf16_f32 v58, v84, v85
    v_exp_f32 v88, v88
    v_cvt_pk_bf16_f32 v59, v86, v87
    v_mfma_f32_32x32x16_bf16 v[96:111], v[44:47], v[52:55], v[96:111]
    ds_read_b128 v[44:47], v3 offset:3072
    s_add_u32 s26, s74, 17006592
    v_exp_f32 v89, v89
    v_exp_f32 v90, v90
    v_cvt_pk_bf16_f32 v60, v88, v89
    v_exp_f32 v91, v91
    v_exp_f32 v92, v92
    v_cvt_pk_bf16_f32 v61, v90, v91
    v_exp_f32 v93, v93
    v_exp_f32 v94, v94
    v_exp_f32 v95, v95
    v_smfmac_f32_16x16x64_bf16 v[12:15], v[8:11], v[48:55], v5
    buffer_load_dwordx4 v1, s[28:31], s26 offen offset:0 sc1 lds
    s_waitcnt lgkmcnt(0)
    v_cvt_pk_bf16_f32 v62, v92, v93
    v_cvt_pk_bf16_f32 v63, v94, v95
    v_mfma_f32_32x32x16_bf16 v[80:95], v[32:35], v[24:27], 0
    ds_read_b128 v[32:35], v3 offset:12288
    v_exp_f32 v64, v64
    v_exp_f32 v65, v65
    v_exp_f32 v66, v66
    v_exp_f32 v67, v67
    v_mfma_f32_32x32x16_bf16 v[96:111], v[40:43], v[56:59], v[96:111]
    ds_read_b128 v[40:43], v3 offset:6144
    v_cvt_pk_bf16_f32 v48, v64, v65
    v_cvt_pk_bf16_f32 v49, v66, v67
    v_exp_f32 v68, v68
    v_exp_f32 v69, v69
    v_exp_f32 v70, v70
    v_mfma_f32_32x32x16_bf16 v[80:95], v[36:39], v[28:31], v[80:95]
    ds_read_b128 v[36:39], v3 offset:13312
    buffer_load_dwordx4 v1, s[28:31], s26 offen offset:1024 sc1 lds
    v_exp_f32 v71, v71
    v_cvt_pk_bf16_f32 v50, v68, v69
    v_exp_f32 v72, v72
    v_cvt_pk_bf16_f32 v51, v70, v71
    v_mfma_f32_32x32x16_bf16 v[96:111], v[44:47], v[60:63], v[96:111]
    ds_read_b128 v[44:47], v3 offset:7168
    buffer_load_dwordx4 v1, s[28:31], s26 offen offset:2048 sc1 lds
    v_exp_f32 v73, v73
    v_exp_f32 v74, v74
    v_cvt_pk_bf16_f32 v52, v72, v73
    v_exp_f32 v75, v75
    v_exp_f32 v76, v76
    v_cvt_pk_bf16_f32 v53, v74, v75
    v_exp_f32 v77, v77
    v_exp_f32 v78, v78
    v_exp_f32 v79, v79
    v_smfmac_f32_16x16x64_bf16 v[12:15], v[8:11], v[56:63], v5
    buffer_load_dwordx4 v1, s[28:31], s26 offen offset:3072 sc1 lds
    s_waitcnt lgkmcnt(0)
    v_cvt_pk_bf16_f32 v54, v76, v77
    v_cvt_pk_bf16_f32 v55, v78, v79
    s_setprio 2
    v_mfma_f32_32x32x16_bf16 v[64:79], v[32:35], v[24:27], 0
    ds_read_b128 v[32:35], v3 offset:16384
    v_exp_f32 v80, v80
    v_exp_f32 v81, v81
    v_exp_f32 v82, v82
    v_exp_f32 v83, v83
    v_mfma_f32_32x32x16_bf16 v[96:111], v[40:43], v[48:51], v[96:111]
    ds_read_b128 v[40:43], v3 offset:10240
    v_cvt_pk_bf16_f32 v56, v80, v81
    v_cvt_pk_bf16_f32 v57, v82, v83
    v_exp_f32 v84, v84
    v_exp_f32 v85, v85
    v_exp_f32 v86, v86
    v_mfma_f32_32x32x16_bf16 v[64:79], v[36:39], v[28:31], v[64:79]
    ds_read_b128 v[36:39], v3 offset:17408
    v_exp_f32 v87, v87
    v_cvt_pk_bf16_f32 v58, v84, v85
    v_exp_f32 v88, v88
    v_cvt_pk_bf16_f32 v59, v86, v87
    v_mfma_f32_32x32x16_bf16 v[96:111], v[44:47], v[52:55], v[96:111]
    ds_read_b128 v[44:47], v3 offset:11264
    v_exp_f32 v89, v89
    v_exp_f32 v90, v90
    v_cvt_pk_bf16_f32 v60, v88, v89
    v_exp_f32 v91, v91
    v_exp_f32 v92, v92
    v_cvt_pk_bf16_f32 v61, v90, v91
    v_exp_f32 v93, v93
    v_exp_f32 v94, v94
    v_exp_f32 v95, v95
    v_smfmac_f32_16x16x64_bf16 v[12:15], v[8:11], v[48:55], v5
    s_waitcnt lgkmcnt(0)
    v_cvt_pk_bf16_f32 v62, v92, v93
    v_cvt_pk_bf16_f32 v63, v94, v95
    v_mfma_f32_32x32x16_bf16 v[80:95], v[32:35], v[24:27], 0
    ds_read_b128 v[32:35], v3 offset:20480
    v_exp_f32 v64, v64
    v_exp_f32 v65, v65
    v_exp_f32 v66, v66
    v_exp_f32 v67, v67
    v_mfma_f32_32x32x16_bf16 v[96:111], v[40:43], v[56:59], v[96:111]
    ds_read_b128 v[40:43], v3 offset:14336
    v_cvt_pk_bf16_f32 v48, v64, v65
    v_cvt_pk_bf16_f32 v49, v66, v67
    v_exp_f32 v68, v68
    v_exp_f32 v69, v69
    v_exp_f32 v70, v70
    v_mfma_f32_32x32x16_bf16 v[80:95], v[36:39], v[28:31], v[80:95]
    ds_read_b128 v[36:39], v3 offset:21504
    v_exp_f32 v71, v71
    v_cvt_pk_bf16_f32 v50, v68, v69
    v_exp_f32 v72, v72
    v_cvt_pk_bf16_f32 v51, v70, v71
    v_mfma_f32_32x32x16_bf16 v[96:111], v[44:47], v[60:63], v[96:111]
    ds_read_b128 v[44:47], v3 offset:15360
    v_exp_f32 v73, v73
    v_exp_f32 v74, v74
    v_cvt_pk_bf16_f32 v52, v72, v73
    v_add_u32 v117, s25, v1
    v_xor_b32 v118, 0x400, v117
    v_add_u32 v119, 0x1000, v117
    v_add_u32 v127, 0x1000, v118
    v_add_u32 v124, s74, v1
    v_xor_b32 v125, 0x4000, v124
    v_exp_f32 v75, v75
    v_exp_f32 v76, v76
    v_cvt_pk_bf16_f32 v53, v74, v75
    v_exp_f32 v77, v77
    v_exp_f32 v78, v78
    v_exp_f32 v79, v79
    v_smfmac_f32_16x16x64_bf16 v[12:15], v[8:11], v[56:63], v5
    s_waitcnt lgkmcnt(0)
    v_cvt_pk_bf16_f32 v54, v76, v77
    v_cvt_pk_bf16_f32 v55, v78, v79
    v_mfma_f32_32x32x16_bf16 v[64:79], v[32:35], v[24:27], 0
    ds_read_b128 v[32:35], v3 offset:24576
    v_exp_f32 v80, v80
    v_exp_f32 v81, v81
    v_exp_f32 v82, v82
    v_exp_f32 v83, v83
    v_mfma_f32_32x32x16_bf16 v[96:111], v[40:43], v[48:51], v[96:111]
    ds_read_b128 v[40:43], v3 offset:18432
    v_cvt_pk_bf16_f32 v56, v80, v81
    v_cvt_pk_bf16_f32 v57, v82, v83
    v_exp_f32 v84, v84
    v_exp_f32 v85, v85
    v_exp_f32 v86, v86
    v_mfma_f32_32x32x16_bf16 v[64:79], v[36:39], v[28:31], v[64:79]
    ds_read_b128 v[36:39], v3 offset:25600
    v_exp_f32 v87, v87
    v_cvt_pk_bf16_f32 v58, v84, v85
    v_exp_f32 v88, v88
    v_cvt_pk_bf16_f32 v59, v86, v87
    v_mfma_f32_32x32x16_bf16 v[96:111], v[44:47], v[52:55], v[96:111]
    ds_read_b128 v[44:47], v3 offset:19456
    v_exp_f32 v89, v89
    v_exp_f32 v90, v90
    v_cvt_pk_bf16_f32 v60, v88, v89
    v_exp_f32 v91, v91
    v_exp_f32 v92, v92
    v_cvt_pk_bf16_f32 v61, v90, v91
    v_exp_f32 v93, v93
    v_exp_f32 v94, v94
    v_exp_f32 v95, v95
    v_smfmac_f32_16x16x64_bf16 v[12:15], v[8:11], v[48:55], v5
    s_waitcnt lgkmcnt(0)
    v_cvt_pk_bf16_f32 v62, v92, v93
    v_cvt_pk_bf16_f32 v63, v94, v95
    v_mfma_f32_32x32x16_bf16 v[80:95], v[32:35], v[24:27], 0
    ds_read_b128 v[32:35], v3 offset:28672
    v_exp_f32 v64, v64
    v_exp_f32 v65, v65
    v_exp_f32 v66, v66
    v_exp_f32 v67, v67
    v_mfma_f32_32x32x16_bf16 v[96:111], v[40:43], v[56:59], v[96:111]
    ds_read_b128 v[40:43], v3 offset:22528
    v_cvt_pk_bf16_f32 v48, v64, v65
    v_cvt_pk_bf16_f32 v49, v66, v67
    v_exp_f32 v68, v68
    v_exp_f32 v69, v69
    v_exp_f32 v70, v70
    v_mfma_f32_32x32x16_bf16 v[80:95], v[36:39], v[28:31], v[80:95]
    ds_read_b128 v[36:39], v3 offset:29696
    v_exp_f32 v71, v71
    v_cvt_pk_bf16_f32 v50, v68, v69
    v_exp_f32 v72, v72
    v_cvt_pk_bf16_f32 v51, v70, v71
    v_mfma_f32_32x32x16_bf16 v[96:111], v[44:47], v[60:63], v[96:111]
    ds_read_b128 v[44:47], v3 offset:23552
    v_exp_f32 v73, v73
    v_exp_f32 v74, v74
    v_cvt_pk_bf16_f32 v52, v72, v73
    v_exp_f32 v75, v75
    v_exp_f32 v76, v76
    v_cvt_pk_bf16_f32 v53, v74, v75
    v_exp_f32 v77, v77
    v_exp_f32 v78, v78
    v_exp_f32 v79, v79
    v_smfmac_f32_16x16x64_bf16 v[12:15], v[8:11], v[56:63], v5
    s_waitcnt lgkmcnt(0)
    v_cvt_pk_bf16_f32 v54, v76, v77
    v_cvt_pk_bf16_f32 v55, v78, v79
    s_waitcnt vmcnt(0)
    s_barrier
    s_cmp_eq_u32 s3, 4
    s_cbranch_scc1 f_sig2
f_sig2_r:
    s_setprio 3
    v_mfma_f32_32x32x16_bf16 v[64:79], v[32:35], v[24:27], 0
    ds_read_b128 v[32:35], v1 offset:0
    v_exp_f32 v80, v80
    v_exp_f32 v81, v81
    v_exp_f32 v82, v82
    v_exp_f32 v83, v83
    v_mfma_f32_32x32x16_bf16 v[96:111], v[40:43], v[48:51], v[96:111]
    ds_read_b128 v[40:43], v3 offset:26624
    v_cvt_pk_bf16_f32 v56, v80, v81
    v_cvt_pk_bf16_f32 v57, v82, v83
    v_exp_f32 v84, v84
    v_exp_f32 v85, v85
    v_exp_f32 v86, v86
    v_mfma_f32_32x32x16_bf16 v[64:79], v[36:39], v[28:31], v[64:79]
    ds_read_b128 v[36:39], v1 offset:1024
    v_exp_f32 v87, v87
    v_cvt_pk_bf16_f32 v58, v84, v85
    v_exp_f32 v88, v88
    v_cvt_pk_bf16_f32 v59, v86, v87
    v_mfma_f32_32x32x16_bf16 v[96:111], v[44:47], v[52:55], v[96:111]
    ds_read_b128 v[44:47], v3 offset:27648
    s_add_u32 m0, s74, 98304
    v_exp_f32 v89, v89
    v_exp_f32 v90, v90
    v_cvt_pk_bf16_f32 v60, v88, v89
    v_exp_f32 v91, v91
    v_exp_f32 v92, v92
    v_cvt_pk_bf16_f32 v61, v90, v91
    v_exp_f32 v93, v93
    v_exp_f32 v94, v94
    v_exp_f32 v95, v95
    v_smfmac_f32_16x16x64_bf16 v[12:15], v[8:11], v[48:55], v5
    buffer_load_dwordx4 v116, s[40:43], s44 offen offset:0 lds
    s_waitcnt lgkmcnt(0)
    v_cvt_pk_bf16_f32 v62, v92, v93
    v_cvt_pk_bf16_f32 v63, v94, v95
    v_mfma_f32_32x32x16_bf16 v[80:95], v[32:35], v[24:27], 0
    ds_read_b128 v[32:35], v1 offset:4096
    v_exp_f32 v64, v64
    v_exp_f32 v65, v65
    v_exp_f32 v66, v66
    v_exp_f32 v67, v67
    v_mfma_f32_32x32x16_bf16 v[96:111], v[40:43], v[56:59], v[96:111]
    ds_read_b128 v[40:43], v3 offset:30720
    v_cvt_pk_bf16_f32 v48, v64, v65
    v_cvt_pk_bf16_f32 v49, v66, v67
    v_exp_f32 v68, v68
    v_exp_f32 v69, v69
    v_exp_f32 v70, v70
    v_mfma_f32_32x32x16_bf16 v[80:95], v[36:39], v[28:31], v[80:95]
    ds_read_b128 v[36:39], v1 offset:5120
    v_exp_f32 v71, v71
    v_cvt_pk_bf16_f32 v50, v68, v69
    v_exp_f32 v72, v72
    v_cvt_pk_bf16_f32 v51, v70, v71
    v_mfma_f32_32x32x16_bf16 v[96:111], v[44:47], v[60:63], v[96:111]
    ds_read_b128 v[44:47], v3 offset:31744
    v_exp_f32 v73, v73
    v_exp_f32 v74, v74
    v_cvt_pk_bf16_f32 v52, v72, v73
    v_exp_f32 v75, v75
    v_exp_f32 v76, v76
    v_cvt_pk_bf16_f32 v53, v74, v75
    v_exp_f32 v77, v77
    v_exp_f32 v78, v78
    v_exp_f32 v79, v79
    v_smfmac_f32_16x16x64_bf16 v[12:15], v[8:11], v[56:63], v5
    buffer_load_dwordx4 v113, s[40:43], s44 offen offset:1024 lds
    s_waitcnt lgkmcnt(0)
    v_cvt_pk_bf16_f32 v54, v76, v77
    v_cvt_pk_bf16_f32 v55, v78, v79
    v_mfma_f32_32x32x16_bf16 v[64:79], v[32:35], v[24:27], 0
    ds_read_b128 v[32:35], v1 offset:8192
    v_exp_f32 v80, v80
    v_exp_f32 v81, v81
    v_exp_f32 v82, v82
    v_exp_f32 v83, v83
    v_mfma_f32_32x32x16_bf16 v[96:111], v[40:43], v[48:51], v[96:111]
    ds_read_b128 v[40:43], v1 offset:2048
    v_cvt_pk_bf16_f32 v56, v80, v81
    v_cvt_pk_bf16_f32 v57, v82, v83
    v_exp_f32 v84, v84
    v_exp_f32 v85, v85
    v_exp_f32 v86, v86
    v_mfma_f32_32x32x16_bf16 v[64:79], v[36:39], v[28:31], v[64:79]
    ds_read_b128 v[36:39], v1 offset:9216
    v_exp_f32 v87, v87
    v_cvt_pk_bf16_f32 v58, v84, v85
    v_exp_f32 v88, v88
    v_cvt_pk_bf16_f32 v59, v86, v87
    v_mfma_f32_32x32x16_bf16 v[96:111], v[44:47], v[52:55], v[96:111]
    ds_read_b128 v[44:47], v1 offset:3072
    v_exp_f32 v89, v89
    v_exp_f32 v90, v90
    v_cvt_pk_bf16_f32 v60, v88, v89
    v_exp_f32 v91, v91
    v_exp_f32 v92, v92
    v_cvt_pk_bf16_f32 v61, v90, v91
    v_exp_f32 v93, v93
    v_exp_f32 v94, v94
    v_exp_f32 v95, v95
    v_smfmac_f32_16x16x64_bf16 v[12:15], v[8:11], v[48:55], v5
    buffer_load_dwordx4 v114, s[40:43], s44 offen offset:2048 lds
    s_waitcnt lgkmcnt(0)
    v_cvt_pk_bf16_f32 v62, v92, v93
    v_cvt_pk_bf16_f32 v63, v94, v95
    s_setprio 2
    v_mfma_f32_32x32x16_bf16 v[80:95], v[32:35], v[24:27], 0
    ds_read_b128 v[32:35], v1 offset:12288
    v_exp_f32 v64, v64
    v_exp_f32 v65, v65
    v_exp_f32 v66, v66
    v_exp_f32 v67, v67
    v_mfma_f32_32x32x16_bf16 v[96:111], v[40:43], v[56:59], v[96:111]
    ds_read_b128 v[40:43], v1 offset:6144
    v_cvt_pk_bf16_f32 v48, v64, v65
    v_cvt_pk_bf16_f32 v49, v66, v67
    v_exp_f32 v68, v68
    v_exp_f32 v69, v69
    v_exp_f32 v70, v70
    v_mfma_f32_32x32x16_bf16 v[80:95], v[36:39], v[28:31], v[80:95]
    ds_read_b128 v[36:39], v1 offset:13312
    v_exp_f32 v71, v71
    v_cvt_pk_bf16_f32 v50, v68, v69
    v_exp_f32 v72, v72
    v_cvt_pk_bf16_f32 v51, v70, v71
    v_mfma_f32_32x32x16_bf16 v[96:111], v[44:47], v[60:63], v[96:111]
    ds_read_b128 v[44:47], v1 offset:7168
    v_exp_f32 v73, v73
    v_exp_f32 v74, v74
    v_cvt_pk_bf16_f32 v52, v72, v73
    v_exp_f32 v75, v75
    v_exp_f32 v76, v76
    v_cvt_pk_bf16_f32 v53, v74, v75
    v_exp_f32 v77, v77
    v_exp_f32 v78, v78
    v_exp_f32 v79, v79
    v_smfmac_f32_16x16x64_bf16 v[12:15], v[8:11], v[56:63], v5
    buffer_load_dwordx4 v115, s[40:43], s44 offen offset:3072 lds
    s_waitcnt lgkmcnt(0)
    v_cvt_pk_bf16_f32 v54, v76, v77
    v_cvt_pk_bf16_f32 v55, v78, v79
    s_cmp_eq_u32 s3, 4
    s_cbranch_scc1 f_pre2
f_pre2_r:
    v_mfma_f32_32x32x16_bf16 v[64:79], v[32:35], v[24:27], 0
    ds_read_b128 v[32:35], v1 offset:16384
    v_exp_f32 v80, v80
    v_exp_f32 v81, v81
    v_exp_f32 v82, v82
    v_exp_f32 v83, v83
    v_mfma_f32_32x32x16_bf16 v[96:111], v[40:43], v[48:51], v[96:111]
    ds_read_b128 v[40:43], v1 offset:10240
    v_cvt_pk_bf16_f32 v56, v80, v81
    v_cvt_pk_bf16_f32 v57, v82, v83
    v_exp_f32 v84, v84
    v_exp_f32 v85, v85
    v_exp_f32 v86, v86
    v_mfma_f32_32x32x16_bf16 v[64:79], v[36:39], v[28:31], v[64:79]
    ds_read_b128 v[36:39], v1 offset:17408
    v_exp_f32 v87, v87
    v_cvt_pk_bf16_f32 v58, v84, v85
    v_exp_f32 v88, v88
    v_cvt_pk_bf16_f32 v59, v86, v87
    v_mfma_f32_32x32x16_bf16 v[96:111], v[44:47], v[52:55], v[96:111]
    ds_read_b128 v[44:47], v1 offset:11264
    v_exp_f32 v89, v89
    v_exp_f32 v90, v90
    v_cvt_pk_bf16_f32 v60, v88, v89
    v_exp_f32 v91, v91
    v_exp_f32 v92, v92
    v_cvt_pk_bf16_f32 v61, v90, v91
    v_exp_f32 v93, v93
    v_exp_f32 v94, v94
    v_exp_f32 v95, v95
    v_smfmac_f32_16x16x64_bf16 v[12:15], v[8:11], v[48:55], v5
    s_waitcnt lgkmcnt(0)
    v_cvt_pk_bf16_f32 v62, v92, v93
    v_cvt_pk_bf16_f32 v63, v94, v95
    v_mfma_f32_32x32x16_bf16 v[80:95], v[32:35], v[24:27], 0
    ds_read_b128 v[32:35], v1 offset:20480
    v_exp_f32 v64, v64
    v_exp_f32 v65, v65
    v_exp_f32 v66, v66
    v_exp_f32 v67, v67
    v_mfma_f32_32x32x16_bf16 v[96:111], v[40:43], v[56:59], v[96:111]
    ds_read_b128 v[40:43], v1 offset:14336
    v_cvt_pk_bf16_f32 v48, v64, v65
    v_cvt_pk_bf16_f32 v49, v66, v67
    v_exp_f32 v68, v68
    v_exp_f32 v69, v69
    v_exp_f32 v70, v70
    v_mfma_f32_32x32x16_bf16 v[80:95], v[36:39], v[28:31], v[80:95]
    ds_read_b128 v[36:39], v1 offset:21504
    v_exp_f32 v71, v71
    v_cvt_pk_bf16_f32 v50, v68, v69
    v_exp_f32 v72, v72
    v_cvt_pk_bf16_f32 v51, v70, v71
    v_mfma_f32_32x32x16_bf16 v[96:111], v[44:47], v[60:63], v[96:111]
    ds_read_b128 v[44:47], v1 offset:15360
    v_exp_f32 v73, v73
    v_exp_f32 v74, v74
    v_cvt_pk_bf16_f32 v52, v72, v73
    v_exp_f32 v75, v75
    v_exp_f32 v76, v76
    v_cvt_pk_bf16_f32 v53, v74, v75
    v_exp_f32 v77, v77
    v_exp_f32 v78, v78
    v_exp_f32 v79, v79
    v_smfmac_f32_16x16x64_bf16 v[12:15], v[8:11], v[56:63], v5
    s_waitcnt lgkmcnt(0)
    v_cvt_pk_bf16_f32 v54, v76, v77
    v_cvt_pk_bf16_f32 v55, v78, v79
    s_cmp_eq_u32 s3, 4
    s_cbranch_scc1 f_poll2
f_poll2_r:
    s_barrier
    s_setprio 3
    v_mfma_f32_32x32x16_bf16 v[64:79], v[32:35], v[24:27], 0
    ds_read_b128 v[32:35], v1 offset:24576
    v_exp_f32 v80, v80
    v_exp_f32 v81, v81
    v_exp_f32 v82, v82
    v_exp_f32 v83, v83
    v_mfma_f32_32x32x16_bf16 v[96:111], v[40:43], v[48:51], v[96:111]
    ds_read_b128 v[40:43], v1 offset:18432
    v_cvt_pk_bf16_f32 v56, v80, v81
    v_cvt_pk_bf16_f32 v57, v82, v83
    v_exp_f32 v84, v84
    v_exp_f32 v85, v85
    v_exp_f32 v86, v86
    v_mfma_f32_32x32x16_bf16 v[64:79], v[36:39], v[28:31], v[64:79]
    ds_read_b128 v[36:39], v1 offset:25600
    v_exp_f32 v87, v87
    v_cvt_pk_bf16_f32 v58, v84, v85
    v_exp_f32 v88, v88
    v_cvt_pk_bf16_f32 v59, v86, v87
    v_mfma_f32_32x32x16_bf16 v[96:111], v[44:47], v[52:55], v[96:111]
    ds_read_b128 v[44:47], v1 offset:19456
    buffer_load_dwordx4 v[128:131], v117, s[28:31], s4 offen sc1
    v_exp_f32 v89, v89
    v_exp_f32 v90, v90
    v_cvt_pk_bf16_f32 v60, v88, v89
    v_exp_f32 v91, v91
    v_exp_f32 v92, v92
    v_cvt_pk_bf16_f32 v61, v90, v91
    v_exp_f32 v93, v93
    v_exp_f32 v94, v94
    v_exp_f32 v95, v95
    v_smfmac_f32_16x16x64_bf16 v[12:15], v[8:11], v[48:55], v5
    buffer_load_dwordx4 v[132:135], v118, s[28:31], s4 offen sc1
    s_waitcnt lgkmcnt(0)
    v_cvt_pk_bf16_f32 v62, v92, v93
    v_cvt_pk_bf16_f32 v63, v94, v95
    v_mfma_f32_32x32x16_bf16 v[80:95], v[32:35], v[24:27], 0
    ds_read_b128 v[32:35], v1 offset:28672
    v_exp_f32 v64, v64
    v_exp_f32 v65, v65
    v_exp_f32 v66, v66
    v_exp_f32 v67, v67
    v_mfma_f32_32x32x16_bf16 v[96:111], v[40:43], v[56:59], v[96:111]
    ds_read_b128 v[40:43], v1 offset:22528
    v_cvt_pk_bf16_f32 v48, v64, v65
    v_cvt_pk_bf16_f32 v49, v66, v67
    v_exp_f32 v68, v68
    v_exp_f32 v69, v69
    v_exp_f32 v70, v70
    v_mfma_f32_32x32x16_bf16 v[80:95], v[36:39], v[28:31], v[80:95]
    ds_read_b128 v[36:39], v1 offset:29696
    v_exp_f32 v71, v71
    v_cvt_pk_bf16_f32 v50, v68, v69
    v_exp_f32 v72, v72
    v_cvt_pk_bf16_f32 v51, v70, v71
    v_mfma_f32_32x32x16_bf16 v[96:111], v[44:47], v[60:63], v[96:111]
    ds_read_b128 v[44:47], v1 offset:23552
    buffer_load_dwordx4 v[136:139], v119, s[28:31], s4 offen sc1
    v_exp_f32 v73, v73
    v_exp_f32 v74, v74
    v_cvt_pk_bf16_f32 v52, v72, v73
    v_exp_f32 v75, v75
    v_exp_f32 v76, v76
    v_cvt_pk_bf16_f32 v53, v74, v75
    v_exp_f32 v77, v77
    v_exp_f32 v78, v78
    v_exp_f32 v79, v79
    v_smfmac_f32_16x16x64_bf16 v[12:15], v[8:11], v[56:63], v5
    buffer_load_dwordx4 v[140:143], v127, s[28:31], s4 offen sc1
    s_waitcnt lgkmcnt(0)
    v_cvt_pk_bf16_f32 v54, v76, v77
    v_cvt_pk_bf16_f32 v55, v78, v79
    v_mfma_f32_32x32x16_bf16 v[64:79], v[32:35], v[24:27], 0
    ds_read_b128 v[32:35], v1 offset:32768
    v_exp_f32 v80, v80
    v_exp_f32 v81, v81
    v_exp_f32 v82, v82
    v_exp_f32 v83, v83
    v_mfma_f32_32x32x16_bf16 v[96:111], v[40:43], v[48:51], v[96:111]
    ds_read_b128 v[40:43], v1 offset:26624
    v_cvt_pk_bf16_f32 v56, v80, v81
    v_cvt_pk_bf16_f32 v57, v82, v83
    v_exp_f32 v84, v84
    v_exp_f32 v85, v85
    v_exp_f32 v86, v86
    v_mfma_f32_32x32x16_bf16 v[64:79], v[36:39], v[28:31], v[64:79]
    ds_read_b128 v[36:39], v1 offset:33792
    v_exp_f32 v87, v87
    v_cvt_pk_bf16_f32 v58, v84, v85
    v_exp_f32 v88, v88
    v_cvt_pk_bf16_f32 v59, v86, v87
    v_mfma_f32_32x32x16_bf16 v[96:111], v[44:47], v[52:55], v[96:111]
    ds_read_b128 v[44:47], v1 offset:27648
    buffer_load_dwordx4 v[144:147], v117, s[28:31], s5 offen sc1
    v_exp_f32 v89, v89
    v_exp_f32 v90, v90
    v_cvt_pk_bf16_f32 v60, v88, v89
    v_exp_f32 v91, v91
    v_exp_f32 v92, v92
    v_cvt_pk_bf16_f32 v61, v90, v91
    v_exp_f32 v93, v93
    v_exp_f32 v94, v94
    v_exp_f32 v95, v95
    v_smfmac_f32_16x16x64_bf16 v[12:15], v[8:11], v[48:55], v5
    buffer_load_dwordx4 v[148:151], v118, s[28:31], s5 offen sc1
    s_waitcnt lgkmcnt(0)
    v_cvt_pk_bf16_f32 v62, v92, v93
    v_cvt_pk_bf16_f32 v63, v94, v95
    v_mfma_f32_32x32x16_bf16 v[80:95], v[32:35], v[24:27], 0
    ds_read_b128 v[32:35], v1 offset:36864
    v_exp_f32 v64, v64
    v_exp_f32 v65, v65
    v_exp_f32 v66, v66
    v_exp_f32 v67, v67
    v_mfma_f32_32x32x16_bf16 v[96:111], v[40:43], v[56:59], v[96:111]
    ds_read_b128 v[40:43], v1 offset:30720
    v_cvt_pk_bf16_f32 v48, v64, v65
    v_cvt_pk_bf16_f32 v49, v66, v67
    v_exp_f32 v68, v68
    v_exp_f32 v69, v69
    v_exp_f32 v70, v70
    v_mfma_f32_32x32x16_bf16 v[80:95], v[36:39], v[28:31], v[80:95]
    ds_read_b128 v[36:39], v1 offset:37888
    s_add_u32 m0, s74, 131072
    v_exp_f32 v71, v71
    v_cvt_pk_bf16_f32 v50, v68, v69
    v_exp_f32 v72, v72
    v_cvt_pk_bf16_f32 v51, v70, v71
    v_mfma_f32_32x32x16_bf16 v[96:111], v[44:47], v[60:63], v[96:111]
    ds_read_b128 v[44:47], v1 offset:31744
    buffer_load_dwordx4 v116, s[40:43], s45 offen offset:0 lds
    v_exp_f32 v73, v73
    v_exp_f32 v74, v74
    v_cvt_pk_bf16_f32 v52, v72, v73
    v_exp_f32 v75, v75
    v_exp_f32 v76, v76
    v_cvt_pk_bf16_f32 v53, v74, v75
    v_exp_f32 v77, v77
    v_exp_f32 v78, v78
    v_exp_f32 v79, v79
    v_smfmac_f32_16x16x64_bf16 v[12:15], v[8:11], v[56:63], v5
    buffer_load_dwordx4 v[152:155], v119, s[28:31], s5 offen sc1
    s_waitcnt lgkmcnt(0)
    v_cvt_pk_bf16_f32 v54, v76, v77
    v_cvt_pk_bf16_f32 v55, v78, v79
    v_mfma_f32_32x32x16_bf16 v[64:79], v[32:35], v[24:27], 0
    ds_read_b128 v[32:35], v1 offset:40960
    v_exp_f32 v80, v80
    v_exp_f32 v81, v81
    v_exp_f32 v82, v82
    v_exp_f32 v83, v83
    v_mfma_f32_32x32x16_bf16 v[96:111], v[40:43], v[48:51], v[96:111]
    ds_read_b128 v[40:43], v1 offset:34816
    v_cvt_pk_bf16_f32 v56, v80, v81
    v_cvt_pk_bf16_f32 v57, v82, v83
    v_exp_f32 v84, v84
    v_exp_f32 v85, v85
    v_exp_f32 v86, v86
    v_mfma_f32_32x32x16_bf16 v[64:79], v[36:39], v[28:31], v[64:79]
    ds_read_b128 v[36:39], v1 offset:41984
    buffer_load_dwordx4 v113, s[40:43], s45 offen offset:1024 lds
    v_exp_f32 v87, v87
    v_cvt_pk_bf16_f32 v58, v84, v85
    v_exp_f32 v88, v88
    v_cvt_pk_bf16_f32 v59, v86, v87
    v_mfma_f32_32x32x16_bf16 v[96:111], v[44:47], v[52:55], v[96:111]
    ds_read_b128 v[44:47], v1 offset:35840
    buffer_load_dwordx4 v[156:159], v127, s[28:31], s5 offen sc1
    v_exp_f32 v89, v89
    v_exp_f32 v90, v90
    v_cvt_pk_bf16_f32 v60, v88, v89
    v_exp_f32 v91, v91
    v_exp_f32 v92, v92
    v_cvt_pk_bf16_f32 v61, v90, v91
    v_exp_f32 v93, v93
    v_exp_f32 v94, v94
    v_exp_f32 v95, v95
    v_smfmac_f32_16x16x64_bf16 v[12:15], v[8:11], v[48:55], v5
    buffer_load_dwordx4 v[160:163], v117, s[28:31], s6 offen sc1
    s_waitcnt lgkmcnt(0)
    v_cvt_pk_bf16_f32 v62, v92, v93
    v_cvt_pk_bf16_f32 v63, v94, v95
    v_mfma_f32_32x32x16_bf16 v[80:95], v[32:35], v[24:27], 0
    ds_read_b128 v[32:35], v1 offset:45056
    v_exp_f32 v64, v64
    v_exp_f32 v65, v65
    v_exp_f32 v66, v66
    v_exp_f32 v67, v67
    v_mfma_f32_32x32x16_bf16 v[96:111], v[40:43], v[56:59], v[96:111]
    ds_read_b128 v[40:43], v1 offset:38912
    v_cvt_pk_bf16_f32 v48, v64, v65
    v_cvt_pk_bf16_f32 v49, v66, v67
    v_exp_f32 v68, v68
    v_exp_f32 v69, v69
    v_exp_f32 v70, v70
    v_mfma_f32_32x32x16_bf16 v[80:95], v[36:39], v[28:31], v[80:95]
    ds_read_b128 v[36:39], v1 offset:46080
    buffer_load_dwordx4 v114, s[40:43], s45 offen offset:2048 lds
    v_exp_f32 v71, v71
    v_cvt_pk_bf16_f32 v50, v68, v69
    v_exp_f32 v72, v72
    v_cvt_pk_bf16_f32 v51, v70, v71
    v_mfma_f32_32x32x16_bf16 v[96:111], v[44:47], v[60:63], v[96:111]
    ds_read_b128 v[44:47], v1 offset:39936
    buffer_load_dwordx4 v[164:167], v118, s[28:31], s6 offen sc1
    v_exp_f32 v73, v73
    v_exp_f32 v74, v74
    v_cvt_pk_bf16_f32 v52, v72, v73
    v_exp_f32 v75, v75
    v_exp_f32 v76, v76
    v_cvt_pk_bf16_f32 v53, v74, v75
    v_exp_f32 v77, v77
    v_exp_f32 v78, v78
    v_exp_f32 v79, v79
    v_smfmac_f32_16x16x64_bf16 v[12:15], v[8:11], v[56:63], v5
    buffer_load_dwordx4 v[168:171], v119, s[28:31], s6 offen sc1
    s_waitcnt lgkmcnt(0)
    v_cvt_pk_bf16_f32 v54, v76, v77
    v_cvt_pk_bf16_f32 v55, v78, v79
    s_setprio 2
    v_mfma_f32_32x32x16_bf16 v[64:79], v[32:35], v[24:27], 0
    ds_read_b128 v[32:35], v1 offset:49152
    v_exp_f32 v80, v80
    v_exp_f32 v81, v81
    v_exp_f32 v82, v82
    v_exp_f32 v83, v83
    v_mfma_f32_32x32x16_bf16 v[96:111], v[40:43], v[48:51], v[96:111]
    ds_read_b128 v[40:43], v1 offset:43008
    v_cvt_pk_bf16_f32 v56, v80, v81
    v_cvt_pk_bf16_f32 v57, v82, v83
    v_exp_f32 v84, v84
    v_exp_f32 v85, v85
    v_exp_f32 v86, v86
    v_mfma_f32_32x32x16_bf16 v[64:79], v[36:39], v[28:31], v[64:79]
    ds_read_b128 v[36:39], v1 offset:50176
    buffer_load_dwordx4 v115, s[40:43], s45 offen offset:3072 lds
    v_exp_f32 v87, v87
    v_cvt_pk_bf16_f32 v58, v84, v85
    v_exp_f32 v88, v88
    v_cvt_pk_bf16_f32 v59, v86, v87
    v_mfma_f32_32x32x16_bf16 v[96:111], v[44:47], v[52:55], v[96:111]
    ds_read_b128 v[44:47], v1 offset:44032
    buffer_load_dwordx4 v[172:175], v127, s[28:31], s6 offen sc1
    v_exp_f32 v89, v89
    v_exp_f32 v90, v90
    v_cvt_pk_bf16_f32 v60, v88, v89
    v_exp_f32 v91, v91
    v_exp_f32 v92, v92
    v_cvt_pk_bf16_f32 v61, v90, v91
    v_exp_f32 v93, v93
    v_exp_f32 v94, v94
    v_exp_f32 v95, v95
    v_smfmac_f32_16x16x64_bf16 v[12:15], v[8:11], v[48:55], v5
    buffer_load_dwordx4 v[176:179], v117, s[28:31], s7 offen sc1
    s_waitcnt lgkmcnt(0)
    v_cvt_pk_bf16_f32 v62, v92, v93
    v_cvt_pk_bf16_f32 v63, v94, v95
    v_mfma_f32_32x32x16_bf16 v[80:95], v[32:35], v[24:27], 0
    ds_read_b128 v[32:35], v1 offset:53248
    v_exp_f32 v64, v64
    v_exp_f32 v65, v65
    v_exp_f32 v66, v66
    v_exp_f32 v67, v67
    v_mfma_f32_32x32x16_bf16 v[96:111], v[40:43], v[56:59], v[96:111]
    ds_read_b128 v[40:43], v1 offset:47104
    v_cvt_pk_bf16_f32 v48, v64, v65
    v_cvt_pk_bf16_f32 v49, v66, v67
    v_exp_f32 v68, v68
    v_exp_f32 v69, v69
    v_exp_f32 v70, v70
    v_mfma_f32_32x32x16_bf16 v[80:95], v[36:39], v[28:31], v[80:95]
    ds_read_b128 v[36:39], v1 offset:54272
    v_exp_f32 v71, v71
    v_cvt_pk_bf16_f32 v50, v68, v69
    v_exp_f32 v72, v72
    v_cvt_pk_bf16_f32 v51, v70, v71
    v_mfma_f32_32x32x16_bf16 v[96:111], v[44:47], v[60:63], v[96:111]
    ds_read_b128 v[44:47], v1 offset:48128
    v_exp_f32 v73, v73
    v_exp_f32 v74, v74
    v_cvt_pk_bf16_f32 v52, v72, v73
    v_exp_f32 v75, v75
    v_exp_f32 v76, v76
    v_cvt_pk_bf16_f32 v53, v74, v75
    v_exp_f32 v77, v77
    v_exp_f32 v78, v78
    v_exp_f32 v79, v79
    v_smfmac_f32_16x16x64_bf16 v[12:15], v[8:11], v[56:63], v5
    buffer_load_dwordx4 v[180:183], v118, s[28:31], s7 offen sc1
    s_waitcnt lgkmcnt(0)
    v_cvt_pk_bf16_f32 v54, v76, v77
    v_cvt_pk_bf16_f32 v55, v78, v79
    v_mfma_f32_32x32x16_bf16 v[64:79], v[32:35], v[24:27], 0
    ds_read_b128 v[32:35], v1 offset:57344
    v_exp_f32 v80, v80
    v_exp_f32 v81, v81
    v_exp_f32 v82, v82
    v_exp_f32 v83, v83
    v_mfma_f32_32x32x16_bf16 v[96:111], v[40:43], v[48:51], v[96:111]
    ds_read_b128 v[40:43], v1 offset:51200
    v_cvt_pk_bf16_f32 v56, v80, v81
    v_cvt_pk_bf16_f32 v57, v82, v83
    v_exp_f32 v84, v84
    v_exp_f32 v85, v85
    v_exp_f32 v86, v86
    v_mfma_f32_32x32x16_bf16 v[64:79], v[36:39], v[28:31], v[64:79]
    ds_read_b128 v[36:39], v1 offset:58368
    v_exp_f32 v87, v87
    v_cvt_pk_bf16_f32 v58, v84, v85
    v_exp_f32 v88, v88
    v_cvt_pk_bf16_f32 v59, v86, v87
    v_mfma_f32_32x32x16_bf16 v[96:111], v[44:47], v[52:55], v[96:111]
    ds_read_b128 v[44:47], v1 offset:52224
    buffer_load_dwordx4 v[184:187], v119, s[28:31], s7 offen sc1
    v_exp_f32 v89, v89
    v_exp_f32 v90, v90
    v_cvt_pk_bf16_f32 v60, v88, v89
    v_exp_f32 v91, v91
    v_exp_f32 v92, v92
    v_cvt_pk_bf16_f32 v61, v90, v91
    v_exp_f32 v93, v93
    v_exp_f32 v94, v94
    v_exp_f32 v95, v95
    v_smfmac_f32_16x16x64_bf16 v[12:15], v[8:11], v[48:55], v5
    buffer_load_dwordx4 v[188:191], v127, s[28:31], s7 offen sc1
    s_waitcnt lgkmcnt(0)
    v_cvt_pk_bf16_f32 v62, v92, v93
    v_cvt_pk_bf16_f32 v63, v94, v95
    v_mfma_f32_32x32x16_bf16 v[80:95], v[32:35], v[24:27], 0
    ds_read_b128 v[32:35], v1 offset:61440
    v_exp_f32 v64, v64
    v_exp_f32 v65, v65
    v_exp_f32 v66, v66
    v_exp_f32 v67, v67
    v_mfma_f32_32x32x16_bf16 v[96:111], v[40:43], v[56:59], v[96:111]
    ds_read_b128 v[40:43], v1 offset:55296
    v_cvt_pk_bf16_f32 v48, v64, v65
    v_cvt_pk_bf16_f32 v49, v66, v67
    v_exp_f32 v68, v68
    v_exp_f32 v69, v69
    v_exp_f32 v70, v70
    v_mfma_f32_32x32x16_bf16 v[80:95], v[36:39], v[28:31], v[80:95]
    ds_read_b128 v[36:39], v1 offset:62464
    v_exp_f32 v71, v71
    v_cvt_pk_bf16_f32 v50, v68, v69
    v_exp_f32 v72, v72
    v_cvt_pk_bf16_f32 v51, v70, v71
    v_mfma_f32_32x32x16_bf16 v[96:111], v[44:47], v[60:63], v[96:111]
    ds_read_b128 v[44:47], v1 offset:56320
    buffer_load_dwordx4 v[192:195], v117, s[28:31], s8 offen sc1
    v_exp_f32 v73, v73
    v_exp_f32 v74, v74
    v_cvt_pk_bf16_f32 v52, v72, v73
    v_exp_f32 v75, v75
    v_exp_f32 v76, v76
    v_cvt_pk_bf16_f32 v53, v74, v75
    v_exp_f32 v77, v77
    v_exp_f32 v78, v78
    v_exp_f32 v79, v79
    v_smfmac_f32_16x16x64_bf16 v[12:15], v[8:11], v[56:63], v5
    buffer_load_dwordx4 v[196:199], v118, s[28:31], s8 offen sc1
    s_waitcnt lgkmcnt(0)
    v_cvt_pk_bf16_f32 v54, v76, v77
    v_cvt_pk_bf16_f32 v55, v78, v79
    v_mfma_f32_32x32x16_bf16 v[64:79], v[32:35], v[24:27], 0
    ds_read_b128 v[32:35], v2 offset:0
    v_exp_f32 v80, v80
    v_exp_f32 v81, v81
    v_exp_f32 v82, v82
    v_exp_f32 v83, v83
    v_mfma_f32_32x32x16_bf16 v[96:111], v[40:43], v[48:51], v[96:111]
    ds_read_b128 v[40:43], v1 offset:59392
    v_cvt_pk_bf16_f32 v56, v80, v81
    v_cvt_pk_bf16_f32 v57, v82, v83
    v_exp_f32 v84, v84
    v_exp_f32 v85, v85
    v_exp_f32 v86, v86
    v_mfma_f32_32x32x16_bf16 v[64:79], v[36:39], v[28:31], v[64:79]
    ds_read_b128 v[36:39], v2 offset:1024
    v_exp_f32 v87, v87
    v_cvt_pk_bf16_f32 v58, v84, v85
    v_exp_f32 v88, v88
    v_cvt_pk_bf16_f32 v59, v86, v87
    v_mfma_f32_32x32x16_bf16 v[96:111], v[44:47], v[52:55], v[96:111]
    ds_read_b128 v[44:47], v1 offset:60416
    v_exp_f32 v89, v89
    v_exp_f32 v90, v90
    v_cvt_pk_bf16_f32 v60, v88, v89
    v_exp_f32 v91, v91
    v_exp_f32 v92, v92
    v_cvt_pk_bf16_f32 v61, v90, v91
    v_exp_f32 v93, v93
    v_exp_f32 v94, v94
    v_exp_f32 v95, v95
    v_smfmac_f32_16x16x64_bf16 v[12:15], v[8:11], v[48:55], v5
    buffer_load_dwordx4 v[200:203], v119, s[28:31], s8 offen sc1
    s_waitcnt lgkmcnt(0)
    v_cvt_pk_bf16_f32 v62, v92, v93
    v_cvt_pk_bf16_f32 v63, v94, v95
    v_mfma_f32_32x32x16_bf16 v[80:95], v[32:35], v[24:27], 0
    ds_read_b128 v[32:35], v2 offset:4096
    v_exp_f32 v64, v64
    v_exp_f32 v65, v65
    v_exp_f32 v66, v66
    v_exp_f32 v67, v67
    v_mfma_f32_32x32x16_bf16 v[96:111], v[40:43], v[56:59], v[96:111]
    ds_read_b128 v[40:43], v1 offset:63488
    v_cvt_pk_bf16_f32 v48, v64, v65
    v_cvt_pk_bf16_f32 v49, v66, v67
    v_exp_f32 v68, v68
    v_exp_f32 v69, v69
    v_exp_f32 v70, v70
    v_mfma_f32_32x32x16_bf16 v[80:95], v[36:39], v[28:31], v[80:95]
    ds_read_b128 v[36:39], v2 offset:5120
    v_exp_f32 v71, v71
    v_cvt_pk_bf16_f32 v50, v68, v69
    v_exp_f32 v72, v72
    v_cvt_pk_bf16_f32 v51, v70, v71
    v_mfma_f32_32x32x16_bf16 v[96:111], v[44:47], v[60:63], v[96:111]
    ds_read_b128 v[44:47], v1 offset:64512
    buffer_load_dwordx4 v[204:207], v127, s[28:31], s8 offen sc1
    v_exp_f32 v73, v73
    v_exp_f32 v74, v74
    v_cvt_pk_bf16_f32 v52, v72, v73
    v_exp_f32 v75, v75
    v_exp_f32 v76, v76
    v_cvt_pk_bf16_f32 v53, v74, v75
    v_exp_f32 v77, v77
    v_exp_f32 v78, v78
    v_exp_f32 v79, v79
    v_smfmac_f32_16x16x64_bf16 v[12:15], v[8:11], v[56:63], v5
    buffer_load_dwordx4 v[208:211], v117, s[28:31], s9 offen sc1
    s_waitcnt lgkmcnt(0)
    v_cvt_pk_bf16_f32 v54, v76, v77
    v_cvt_pk_bf16_f32 v55, v78, v79
    s_waitcnt vmcnt(10)
    s_barrier
    s_setprio 3
    v_mfma_f32_32x32x16_bf16 v[64:79], v[32:35], v[24:27], 0
    ds_read_b128 v[32:35], v2 offset:8192
    v_exp_f32 v80, v80
    v_exp_f32 v81, v81
    v_exp_f32 v82, v82
    v_exp_f32 v83, v83
    v_mfma_f32_32x32x16_bf16 v[96:111], v[40:43], v[48:51], v[96:111]
    ds_read_b128 v[40:43], v2 offset:2048
    s_add_u32 m0, s74, 0
    v_cvt_pk_bf16_f32 v56, v80, v81
    v_cvt_pk_bf16_f32 v57, v82, v83
    v_exp_f32 v84, v84
    v_exp_f32 v85, v85
    v_exp_f32 v86, v86
    v_mfma_f32_32x32x16_bf16 v[64:79], v[36:39], v[28:31], v[64:79]
    ds_read_b128 v[36:39], v2 offset:9216
    buffer_load_dwordx4 v116, s[40:43], s46 offen offset:0 lds
    v_exp_f32 v87, v87
    v_cvt_pk_bf16_f32 v58, v84, v85
    v_exp_f32 v88, v88
    v_cvt_pk_bf16_f32 v59, v86, v87
    v_mfma_f32_32x32x16_bf16 v[96:111], v[44:47], v[52:55], v[96:111]
    ds_read_b128 v[44:47], v2 offset:3072
    buffer_load_dwordx4 v[212:215], v118, s[28:31], s9 offen sc1
    v_exp_f32 v89, v89
    v_exp_f32 v90, v90
    v_cvt_pk_bf16_f32 v60, v88, v89
    v_exp_f32 v91, v91
    v_exp_f32 v92, v92
    v_cvt_pk_bf16_f32 v61, v90, v91
    v_exp_f32 v93, v93
    v_exp_f32 v94, v94
    v_exp_f32 v95, v95
    v_smfmac_f32_16x16x64_bf16 v[12:15], v[8:11], v[48:55], v5
    buffer_load_dwordx4 v[216:219], v119, s[28:31], s9 offen sc1
    s_waitcnt lgkmcnt(0)
    v_cvt_pk_bf16_f32 v62, v92, v93
    v_cvt_pk_bf16_f32 v63, v94, v95
    v_mfma_f32_32x32x16_bf16 v[80:95], v[32:35], v[24:27], 0
    ds_read_b128 v[32:35], v2 offset:12288
    v_exp_f32 v64, v64
    v_exp_f32 v65, v65
    v_exp_f32 v66, v66
    v_exp_f32 v67, v67
    v_mfma_f32_32x32x16_bf16 v[96:111], v[40:43], v[56:59], v[96:111]
    ds_read_b128 v[40:43], v2 offset:6144
    v_cvt_pk_bf16_f32 v48, v64, v65
    v_cvt_pk_bf16_f32 v49, v66, v67
    v_exp_f32 v68, v68
    v_exp_f32 v69, v69
    v_exp_f32 v70, v70
    v_mfma_f32_32x32x16_bf16 v[80:95], v[36:39], v[28:31], v[80:95]
    ds_read_b128 v[36:39], v2 offset:13312
    buffer_load_dwordx4 v113, s[40:43], s46 offen offset:1024 lds
    v_exp_f32 v71, v71
    v_cvt_pk_bf16_f32 v50, v68, v69
    v_exp_f32 v72, v72
    v_cvt_pk_bf16_f32 v51, v70, v71
    v_mfma_f32_32x32x16_bf16 v[96:111], v[44:47], v[60:63], v[96:111]
    ds_read_b128 v[44:47], v2 offset:7168
    buffer_load_dwordx4 v[220:223], v127, s[28:31], s9 offen sc1
    v_exp_f32 v73, v73
    v_exp_f32 v74, v74
    v_cvt_pk_bf16_f32 v52, v72, v73
    v_exp_f32 v75, v75
    v_exp_f32 v76, v76
    v_cvt_pk_bf16_f32 v53, v74, v75
    v_exp_f32 v77, v77
    v_exp_f32 v78, v78
    v_exp_f32 v79, v79
    v_smfmac_f32_16x16x64_bf16 v[12:15], v[8:11], v[56:63], v5
    buffer_load_dwordx4 v[224:227], v117, s[28:31], s10 offen sc1
    s_waitcnt lgkmcnt(0)
    v_cvt_pk_bf16_f32 v54, v76, v77
    v_cvt_pk_bf16_f32 v55, v78, v79
    v_mfma_f32_32x32x16_bf16 v[64:79], v[32:35], v[24:27], 0
    ds_read_b128 v[32:35], v2 offset:16384
    v_exp_f32 v80, v80
    v_exp_f32 v81, v81
    v_exp_f32 v82, v82
    v_exp_f32 v83, v83
    v_mfma_f32_32x32x16_bf16 v[96:111], v[40:43], v[48:51], v[96:111]
    ds_read_b128 v[40:43], v2 offset:10240
    v_cvt_pk_bf16_f32 v56, v80, v81
    v_cvt_pk_bf16_f32 v57, v82, v83
    v_exp_f32 v84, v84
    v_exp_f32 v85, v85
    v_exp_f32 v86, v86
    v_mfma_f32_32x32x16_bf16 v[64:79], v[36:39], v[28:31], v[64:79]
    ds_read_b128 v[36:39], v2 offset:17408
    v_exp_f32 v87, v87
    v_cvt_pk_bf16_f32 v58, v84, v85
    v_exp_f32 v88, v88
    v_cvt_pk_bf16_f32 v59, v86, v87
    v_mfma_f32_32x32x16_bf16 v[96:111], v[44:47], v[52:55], v[96:111]
    ds_read_b128 v[44:47], v2 offset:11264
    buffer_load_dwordx4 v114, s[40:43], s46 offen offset:2048 lds
    v_exp_f32 v89, v89
    v_exp_f32 v90, v90
    v_cvt_pk_bf16_f32 v60, v88, v89
    v_exp_f32 v91, v91
    v_exp_f32 v92, v92
    v_cvt_pk_bf16_f32 v61, v90, v91
    v_exp_f32 v93, v93
    v_exp_f32 v94, v94
    v_exp_f32 v95, v95
    v_smfmac_f32_16x16x64_bf16 v[12:15], v[8:11], v[48:55], v5
    buffer_load_dwordx4 v[228:231], v118, s[28:31], s10 offen sc1
    s_waitcnt lgkmcnt(0)
    v_cvt_pk_bf16_f32 v62, v92, v93
    v_cvt_pk_bf16_f32 v63, v94, v95
    v_mfma_f32_32x32x16_bf16 v[80:95], v[32:35], v[24:27], 0
    ds_read_b128 v[32:35], v2 offset:20480
    v_exp_f32 v64, v64
    v_exp_f32 v65, v65
    v_exp_f32 v66, v66
    v_exp_f32 v67, v67
    v_mfma_f32_32x32x16_bf16 v[96:111], v[40:43], v[56:59], v[96:111]
    ds_read_b128 v[40:43], v2 offset:14336
    v_cvt_pk_bf16_f32 v48, v64, v65
    v_cvt_pk_bf16_f32 v49, v66, v67
    v_exp_f32 v68, v68
    v_exp_f32 v69, v69
    v_exp_f32 v70, v70
    v_mfma_f32_32x32x16_bf16 v[80:95], v[36:39], v[28:31], v[80:95]
    ds_read_b128 v[36:39], v2 offset:21504
    buffer_load_dwordx4 v115, s[40:43], s46 offen offset:3072 lds
    v_exp_f32 v71, v71
    v_cvt_pk_bf16_f32 v50, v68, v69
    v_exp_f32 v72, v72
    v_cvt_pk_bf16_f32 v51, v70, v71
    v_mfma_f32_32x32x16_bf16 v[96:111], v[44:47], v[60:63], v[96:111]
    ds_read_b128 v[44:47], v2 offset:15360
    buffer_load_dwordx4 v[232:235], v119, s[28:31], s10 offen sc1
    v_exp_f32 v73, v73
    v_exp_f32 v74, v74
    v_cvt_pk_bf16_f32 v52, v72, v73
    v_exp_f32 v75, v75
    v_exp_f32 v76, v76
    v_cvt_pk_bf16_f32 v53, v74, v75
    v_exp_f32 v77, v77
    v_exp_f32 v78, v78
    v_exp_f32 v79, v79
    v_smfmac_f32_16x16x64_bf16 v[12:15], v[8:11], v[56:63], v5
    buffer_load_dwordx4 v[236:239], v127, s[28:31], s10 offen sc1
    s_waitcnt lgkmcnt(0)
    v_cvt_pk_bf16_f32 v54, v76, v77
    v_cvt_pk_bf16_f32 v55, v78, v79
    s_setprio 2
    v_mfma_f32_32x32x16_bf16 v[64:79], v[32:35], v[24:27], 0
    ds_read_b128 v[32:35], v2 offset:24576
    v_exp_f32 v80, v80
    v_exp_f32 v81, v81
    v_exp_f32 v82, v82
    v_exp_f32 v83, v83
    v_mfma_f32_32x32x16_bf16 v[96:111], v[40:43], v[48:51], v[96:111]
    ds_read_b128 v[40:43], v2 offset:18432
    s_add_u32 m0, s74, 32768
    v_cvt_pk_bf16_f32 v56, v80, v81
    v_cvt_pk_bf16_f32 v57, v82, v83
    v_exp_f32 v84, v84
    v_exp_f32 v85, v85
    v_exp_f32 v86, v86
    v_mfma_f32_32x32x16_bf16 v[64:79], v[36:39], v[28:31], v[64:79]
    ds_read_b128 v[36:39], v2 offset:25600
    buffer_load_dwordx4 v116, s[40:43], s47 offen offset:0 lds
    v_exp_f32 v87, v87
    v_cvt_pk_bf16_f32 v58, v84, v85
    v_exp_f32 v88, v88
    v_cvt_pk_bf16_f32 v59, v86, v87
    v_mfma_f32_32x32x16_bf16 v[96:111], v[44:47], v[52:55], v[96:111]
    ds_read_b128 v[44:47], v2 offset:19456
    buffer_load_dwordx4 v[240:243], v117, s[28:31], s11 offen sc1
    v_exp_f32 v89, v89
    v_exp_f32 v90, v90
    v_cvt_pk_bf16_f32 v60, v88, v89
    v_exp_f32 v91, v91
    v_exp_f32 v92, v92
    v_cvt_pk_bf16_f32 v61, v90, v91
    v_exp_f32 v93, v93
    v_exp_f32 v94, v94
    v_exp_f32 v95, v95
    v_smfmac_f32_16x16x64_bf16 v[12:15], v[8:11], v[48:55], v5
    buffer_load_dwordx4 v[244:247], v118, s[28:31], s11 offen sc1
    s_waitcnt lgkmcnt(0)
    v_cvt_pk_bf16_f32 v62, v92, v93
    v_cvt_pk_bf16_f32 v63, v94, v95
    v_mfma_f32_32x32x16_bf16 v[80:95], v[32:35], v[24:27], 0
    ds_read_b128 v[32:35], v2 offset:28672
    v_exp_f32 v64, v64
    v_exp_f32 v65, v65
    v_exp_f32 v66, v66
    v_exp_f32 v67, v67
    v_mfma_f32_32x32x16_bf16 v[96:111], v[40:43], v[56:59], v[96:111]
    ds_read_b128 v[40:43], v2 offset:22528
    v_cvt_pk_bf16_f32 v48, v64, v65
    v_cvt_pk_bf16_f32 v49, v66, v67
    v_exp_f32 v68, v68
    v_exp_f32 v69, v69
    v_exp_f32 v70, v70
    v_mfma_f32_32x32x16_bf16 v[80:95], v[36:39], v[28:31], v[80:95]
    ds_read_b128 v[36:39], v2 offset:29696
    v_exp_f32 v71, v71
    v_cvt_pk_bf16_f32 v50, v68, v69
    v_exp_f32 v72, v72
    v_cvt_pk_bf16_f32 v51, v70, v71
    v_mfma_f32_32x32x16_bf16 v[96:111], v[44:47], v[60:63], v[96:111]
    ds_read_b128 v[44:47], v2 offset:23552
    buffer_load_dwordx4 v113, s[40:43], s47 offen offset:1024 lds
    v_exp_f32 v73, v73
    v_exp_f32 v74, v74
    v_cvt_pk_bf16_f32 v52, v72, v73
    v_exp_f32 v75, v75
    v_exp_f32 v76, v76
    v_cvt_pk_bf16_f32 v53, v74, v75
    v_exp_f32 v77, v77
    v_exp_f32 v78, v78
    v_exp_f32 v79, v79
    v_smfmac_f32_16x16x64_bf16 v[12:15], v[8:11], v[56:63], v5
    buffer_load_dwordx4 v[248:251], v119, s[28:31], s11 offen sc1
    s_waitcnt lgkmcnt(0)
    v_cvt_pk_bf16_f32 v54, v76, v77
    v_cvt_pk_bf16_f32 v55, v78, v79
    v_mfma_f32_32x32x16_bf16 v[64:79], v[32:35], v[24:27], 0
    ds_read_b128 v[32:35], v2 offset:28672
    v_exp_f32 v80, v80
    v_exp_f32 v81, v81
    v_exp_f32 v82, v82
    v_exp_f32 v83, v83
    v_mfma_f32_32x32x16_bf16 v[96:111], v[40:43], v[48:51], v[96:111]
    ds_read_b128 v[40:43], v2 offset:26624
    v_cvt_pk_bf16_f32 v56, v80, v81
    v_cvt_pk_bf16_f32 v57, v82, v83
    v_exp_f32 v84, v84
    v_exp_f32 v85, v85
    v_exp_f32 v86, v86
    v_mfma_f32_32x32x16_bf16 v[64:79], v[36:39], v[28:31], v[64:79]
    ds_read_b128 v[36:39], v2 offset:29696
    v_exp_f32 v87, v87
    v_cvt_pk_bf16_f32 v58, v84, v85
    v_exp_f32 v88, v88
    v_cvt_pk_bf16_f32 v59, v86, v87
    v_mfma_f32_32x32x16_bf16 v[96:111], v[44:47], v[52:55], v[96:111]
    ds_read_b128 v[44:47], v2 offset:27648
    buffer_load_dwordx4 v114, s[40:43], s47 offen offset:2048 lds
    v_exp_f32 v89, v89
    v_exp_f32 v90, v90
    v_cvt_pk_bf16_f32 v60, v88, v89
    v_exp_f32 v91, v91
    v_exp_f32 v92, v92
    v_cvt_pk_bf16_f32 v61, v90, v91
    v_exp_f32 v93, v93
    v_exp_f32 v94, v94
    v_exp_f32 v95, v95
    v_smfmac_f32_16x16x64_bf16 v[12:15], v[8:11], v[48:55], v5
    buffer_load_dwordx4 v[252:255], v127, s[28:31], s11 offen sc1
    s_waitcnt lgkmcnt(0)
    v_cvt_pk_bf16_f32 v62, v92, v93
    v_cvt_pk_bf16_f32 v63, v94, v95
    v_mfma_f32_32x32x16_bf16 v[80:95], v[32:35], v[24:27], 0
    ds_read_b128 v[32:35], v2 offset:28672
    v_exp_f32 v64, v64
    v_exp_f32 v65, v65
    v_exp_f32 v66, v66
    v_exp_f32 v67, v67
    v_mfma_f32_32x32x16_bf16 v[96:111], v[40:43], v[56:59], v[96:111]
    ds_read_b128 v[40:43], v2 offset:30720
    v_cvt_pk_bf16_f32 v48, v64, v65
    v_cvt_pk_bf16_f32 v49, v66, v67
    v_exp_f32 v68, v68
    v_exp_f32 v69, v69
    v_exp_f32 v70, v70
    v_mfma_f32_32x32x16_bf16 v[80:95], v[36:39], v[28:31], v[80:95]
    ds_read_b128 v[36:39], v2 offset:29696
    v_exp_f32 v71, v71
    v_cvt_pk_bf16_f32 v50, v68, v69
    v_exp_f32 v72, v72
    v_cvt_pk_bf16_f32 v51, v70, v71
    v_mfma_f32_32x32x16_bf16 v[96:111], v[44:47], v[60:63], v[96:111]
    ds_read_b128 v[44:47], v2 offset:31744
    v_exp_f32 v73, v73
    v_exp_f32 v74, v74
    v_cvt_pk_bf16_f32 v52, v72, v73
    v_exp_f32 v75, v75
    v_exp_f32 v76, v76
    v_cvt_pk_bf16_f32 v53, v74, v75
    v_exp_f32 v77, v77
    v_exp_f32 v78, v78
    v_exp_f32 v79, v79
    v_smfmac_f32_16x16x64_bf16 v[12:15], v[8:11], v[56:63], v5
    buffer_load_dwordx4 v115, s[40:43], s47 offen offset:3072 lds
    s_waitcnt lgkmcnt(0)
    v_cvt_pk_bf16_f32 v54, v76, v77
    v_cvt_pk_bf16_f32 v55, v78, v79
    v_mfma_f32_32x32x16_bf16 v[96:111], v[40:43], v[48:51], v[96:111]
    s_nop 0
    v_mfma_f32_32x32x16_bf16 v[96:111], v[44:47], v[52:55], v[96:111]
    v_smfmac_f32_16x16x64_bf16 v[12:15], v[8:11], v[48:55], v5
    s_sub_u32 s4, s4, 0x10000
    s_sub_u32 s5, s5, 0x10000
    s_sub_u32 s6, s6, 0x10000
    s_sub_u32 s7, s7, 0x10000
    s_sub_u32 s8, s8, 0x10000
    s_sub_u32 s9, s9, 0x10000
    s_sub_u32 s10, s10, 0x10000
    s_sub_u32 s11, s11, 0x10000
    s_setprio 0
    v_lshrrev_b32 v20, 4, v0
    v_bfe_u32 v21, v0, 2, 2
    v_and_b32 v22, 1, v20
    v_lshl_add_u32 v22, v22, 2, v21
    v_lshrrev_b32 v23, 1, v20
    v_lshl_add_u32 v23, v23, 4, v22
    v_lshlrev_b32 v23, 7, v23
    v_and_b32 v20, 3, v0
    v_lshl_add_u32 v23, v20, 3, v23
    s_lshr_b32 s56, s3, 2
    s_lshl_b32 s56, s56, 12
    s_add_u32 s56, s56, 98304
    v_add_u32 v23, s56, v23
    v_lshrrev_b32 v22, 1, v22
    v_xor_b32 v20, 0, v22
    v_lshl_add_u32 v16, v20, 5, v23
    v_xor_b32 v20, 1, v22
    v_lshl_add_u32 v17, v20, 5, v23
    v_xor_b32 v20, 2, v22
    v_lshl_add_u32 v18, v20, 5, v23
    v_xor_b32 v20, 3, v22
    v_lshl_add_u32 v19, v20, 5, v23
    s_mov_b32 s63, 0
f_normA:
    v_add_f32 v7, v12, v13
    v_rcp_f32 v64, v7
    s_nop 0
    v_mul_f32 v64, v64, v4
    v_pk_mul_f32 v[96:97], v[96:97], v[64:65] op_sel_hi:[1,0]
    v_pk_mul_f32 v[98:99], v[98:99], v[64:65] op_sel_hi:[1,0]
    v_pk_mul_f32 v[100:101], v[100:101], v[64:65] op_sel_hi:[1,0]
    v_pk_mul_f32 v[102:103], v[102:103], v[64:65] op_sel_hi:[1,0]
    v_pk_mul_f32 v[104:105], v[104:105], v[64:65] op_sel_hi:[1,0]
    v_pk_mul_f32 v[106:107], v[106:107], v[64:65] op_sel_hi:[1,0]
    v_pk_mul_f32 v[108:109], v[108:109], v[64:65] op_sel_hi:[1,0]
    v_pk_mul_f32 v[110:111], v[110:111], v[64:65] op_sel_hi:[1,0]
    v_pk_add_f32 v[66:67], v[96:97], v[98:99]
    v_pk_add_f32 v[66:67], v[66:67], v[100:101]
    v_pk_add_f32 v[66:67], v[66:67], v[102:103]
    v_pk_add_f32 v[66:67], v[66:67], v[104:105]
    v_pk_add_f32 v[66:67], v[66:67], v[106:107]
    v_pk_add_f32 v[66:67], v[66:67], v[108:109]
    v_pk_add_f32 v[66:67], v[66:67], v[110:111]
    v_sub_f32 v66, v66, v66
    v_fma_f32 v66, v67, v66, v7
    v_cmp_le_f32 vcc, 528482304, v66
    s_mov_b64 s[56:57], vcc
    v_cmp_ge_f32 vcc, 1602224128, v66
    v_cvt_pk_bf16_f32 v64, v96, v97
    v_cvt_pk_bf16_f32 v65, v98, v99
    v_cvt_pk_bf16_f32 v66, v100, v101
    v_cvt_pk_bf16_f32 v67, v102, v103
    v_cvt_pk_bf16_f32 v68, v104, v105
    v_cvt_pk_bf16_f32 v69, v106, v107
    v_cvt_pk_bf16_f32 v70, v108, v109
    v_cvt_pk_bf16_f32 v71, v110, v111
    s_and_b64 vcc, vcc, s[56:57]
    s_cmp_eq_u64 vcc, -1
    s_cselect_b32 s62, 1, s63
    s_cmp_eq_u32 s62, 0
    s_cbranch_scc1 f_slowA
    buffer_store_dwordx4 v[64:67], v112, s[28:31], s21 offen sc1
    buffer_store_dwordx4 v[68:71], v112, s[28:31], s21 offen offset:512 sc1
    ds_read_b64_tr_b16 v[32:33], v16 offset:0
    ds_read_b64_tr_b16 v[34:35], v16 offset:1024
    ds_read_b64_tr_b16 v[36:37], v16 offset:8192
    ds_read_b64_tr_b16 v[38:39], v16 offset:9216
    ds_read_b64_tr_b16 v[40:41], v17 offset:0
    ds_read_b64_tr_b16 v[42:43], v17 offset:1024
    ds_read_b64_tr_b16 v[44:45], v17 offset:8192
    ds_read_b64_tr_b16 v[46:47], v17 offset:9216
    ds_read_b64_tr_b16 v[48:49], v18 offset:0
    ds_read_b64_tr_b16 v[50:51], v18 offset:1024
    ds_read_b64_tr_b16 v[52:53], v18 offset:8192
    ds_read_b64_tr_b16 v[54:55], v18 offset:9216
    s_waitcnt lgkmcnt(8)
    ds_read_b64_tr_b16 v[56:57], v19 offset:0
    ds_read_b64_tr_b16 v[58:59], v19 offset:1024
    ds_read_b64_tr_b16 v[60:61], v19 offset:8192
    ds_read_b64_tr_b16 v[62:63], v19 offset:9216
    s_waitcnt lgkmcnt(4) vmcnt(36)
    v_mfma_f32_16x16x32_bf16 v[64:67], v[32:35], v[128:131], 0
    v_mfma_f32_16x16x32_bf16 v[64:67], v[36:39], v[136:139], v[64:67]
    v_mfma_f32_16x16x32_bf16 v[80:83], v[36:39], v[140:143], 0
    v_mfma_f32_16x16x32_bf16 v[80:83], v[32:35], v[132:135], v[80:83]
    v_mfma_f32_16x16x32_bf16 v[84:87], v[40:43], v[132:135], 0
    ds_read_b64_tr_b16 v[32:33], v16 offset:16384
    v_mfma_f32_16x16x32_bf16 v[84:87], v[44:47], v[140:143], v[84:87]
    ds_read_b64_tr_b16 v[34:35], v16 offset:17408
    v_mfma_f32_16x16x32_bf16 v[68:71], v[44:47], v[136:139], 0
    ds_read_b64_tr_b16 v[36:37], v16 offset:24576
    v_mfma_f32_16x16x32_bf16 v[68:71], v[40:43], v[128:131], v[68:71]
    ds_read_b64_tr_b16 v[38:39], v16 offset:25600
    s_waitcnt lgkmcnt(4)
    v_mfma_f32_16x16x32_bf16 v[72:75], v[48:51], v[128:131], 0
    ds_read_b64_tr_b16 v[40:41], v17 offset:16384
    v_mfma_f32_16x16x32_bf16 v[72:75], v[52:55], v[136:139], v[72:75]
    ds_read_b64_tr_b16 v[42:43], v17 offset:17408
    v_mfma_f32_16x16x32_bf16 v[88:91], v[52:55], v[140:143], 0
    ds_read_b64_tr_b16 v[44:45], v17 offset:24576
    v_mfma_f32_16x16x32_bf16 v[88:91], v[48:51], v[132:135], v[88:91]
    ds_read_b64_tr_b16 v[46:47], v17 offset:25600
    v_mfma_f32_16x16x32_bf16 v[92:95], v[56:59], v[132:135], 0
    ds_read_b64_tr_b16 v[48:49], v18 offset:16384
    v_mfma_f32_16x16x32_bf16 v[92:95], v[60:63], v[140:143], v[92:95]
    ds_read_b64_tr_b16 v[50:51], v18 offset:17408
    v_mfma_f32_16x16x32_bf16 v[76:79], v[60:63], v[136:139], 0
    ds_read_b64_tr_b16 v[52:53], v18 offset:24576
    v_mfma_f32_16x16x32_bf16 v[76:79], v[56:59], v[128:131], v[76:79]
    ds_read_b64_tr_b16 v[54:55], v18 offset:25600
    s_waitcnt lgkmcnt(4)
    v_mfma_f32_16x16x32_bf16 v[64:67], v[32:35], v[144:147], v[64:67]
    ds_read_b64_tr_b16 v[56:57], v19 offset:16384
    v_mfma_f32_16x16x32_bf16 v[64:67], v[36:39], v[152:155], v[64:67]
    ds_read_b64_tr_b16 v[58:59], v19 offset:17408
    v_mfma_f32_16x16x32_bf16 v[80:83], v[36:39], v[156:159], v[80:83]
    ds_read_b64_tr_b16 v[60:61], v19 offset:24576
    v_mfma_f32_16x16x32_bf16 v[80:83], v[32:35], v[148:151], v[80:83]
    ds_read_b64_tr_b16 v[62:63], v19 offset:25600
    v_add_u32 v16, 32768, v16
    v_mfma_f32_16x16x32_bf16 v[84:87], v[40:43], v[148:151], v[84:87]
    ds_read_b64_tr_b16 v[32:33], v16 offset:0
    v_mfma_f32_16x16x32_bf16 v[84:87], v[44:47], v[156:159], v[84:87]
    ds_read_b64_tr_b16 v[34:35], v16 offset:1024
    v_mfma_f32_16x16x32_bf16 v[68:71], v[44:47], v[152:155], v[68:71]
    ds_read_b64_tr_b16 v[36:37], v16 offset:8192
    v_mfma_f32_16x16x32_bf16 v[68:71], v[40:43], v[144:147], v[68:71]
    ds_read_b64_tr_b16 v[38:39], v16 offset:9216
    s_waitcnt lgkmcnt(4)
    v_add_u32 v17, 32768, v17
    v_mfma_f32_16x16x32_bf16 v[72:75], v[48:51], v[144:147], v[72:75]
    ds_read_b64_tr_b16 v[40:41], v17 offset:0
    v_mfma_f32_16x16x32_bf16 v[72:75], v[52:55], v[152:155], v[72:75]
    ds_read_b64_tr_b16 v[42:43], v17 offset:1024
    v_mfma_f32_16x16x32_bf16 v[88:91], v[52:55], v[156:159], v[88:91]
    ds_read_b64_tr_b16 v[44:45], v17 offset:8192
    v_mfma_f32_16x16x32_bf16 v[88:91], v[48:51], v[148:151], v[88:91]
    ds_read_b64_tr_b16 v[46:47], v17 offset:9216
    v_add_u32 v18, 32768, v18
    v_mfma_f32_16x16x32_bf16 v[92:95], v[56:59], v[148:151], v[92:95]
    s_waitcnt vmcnt(0)
    s_barrier
    s_cmp_lg_u32 s3, 4
    s_cbranch_scc1 f_y1
    s_mov_b64 exec, 1
    v_mov_b32 v7, s64
    v_mov_b32 v3, 0
    s_lshl_b32 s56, s48, 4
    s_add_u32 s56, s56, s49
    s_lshl_b32 s56, s56, 4
    s_add_u32 s56, s56, 4210688
    buffer_store_dword v7, v3, s[28:31], s56 offen sc1
    s_mov_b64 exec, -1
f_y1:
    ds_read_b64_tr_b16 v[48:49], v18 offset:0
    v_mfma_f32_16x16x32_bf16 v[92:95], v[60:63], v[156:159], v[92:95]
    ds_read_b64_tr_b16 v[50:51], v18 offset:1024
    s_add_u32 m0, s74, 65536
    s_nop 0
    buffer_load_dwordx4 v116, s[36:39], s44 offen offset:0 lds
    v_mfma_f32_16x16x32_bf16 v[76:79], v[60:63], v[152:155], v[76:79]
    ds_read_b64_tr_b16 v[52:53], v18 offset:8192
    v_mfma_f32_16x16x32_bf16 v[76:79], v[56:59], v[144:147], v[76:79]
    ds_read_b64_tr_b16 v[54:55], v18 offset:9216
    buffer_load_dwordx4 v113, s[36:39], s44 offen offset:1024 lds
    s_waitcnt lgkmcnt(4)
    v_add_u32 v19, 32768, v19
    v_mfma_f32_16x16x32_bf16 v[64:67], v[32:35], v[160:163], v[64:67]
    ds_read_b64_tr_b16 v[56:57], v19 offset:0
    v_mfma_f32_16x16x32_bf16 v[64:67], v[36:39], v[168:171], v[64:67]
    ds_read_b64_tr_b16 v[58:59], v19 offset:1024
    buffer_load_dwordx4 v114, s[36:39], s44 offen offset:2048 lds
    v_mfma_f32_16x16x32_bf16 v[80:83], v[36:39], v[172:175], v[80:83]
    ds_read_b64_tr_b16 v[60:61], v19 offset:8192
    v_mfma_f32_16x16x32_bf16 v[80:83], v[32:35], v[164:167], v[80:83]
    ds_read_b64_tr_b16 v[62:63], v19 offset:9216
    buffer_load_dwordx4 v115, s[36:39], s44 offen offset:3072 lds
    v_mfma_f32_16x16x32_bf16 v[84:87], v[40:43], v[164:167], v[84:87]
    ds_read_b64_tr_b16 v[32:33], v16 offset:16384
    v_mfma_f32_16x16x32_bf16 v[84:87], v[44:47], v[172:175], v[84:87]
    ds_read_b64_tr_b16 v[34:35], v16 offset:17408
    v_mfma_f32_16x16x32_bf16 v[68:71], v[44:47], v[168:171], v[68:71]
    ds_read_b64_tr_b16 v[36:37], v16 offset:24576
    v_mfma_f32_16x16x32_bf16 v[68:71], v[40:43], v[160:163], v[68:71]
    ds_read_b64_tr_b16 v[38:39], v16 offset:25600
    s_waitcnt lgkmcnt(4)
    v_mfma_f32_16x16x32_bf16 v[72:75], v[48:51], v[160:163], v[72:75]
    ds_read_b64_tr_b16 v[40:41], v17 offset:16384
    v_mfma_f32_16x16x32_bf16 v[72:75], v[52:55], v[168:171], v[72:75]
    ds_read_b64_tr_b16 v[42:43], v17 offset:17408
    s_add_u32 m0, s74, 98304
    s_nop 0
    buffer_load_dwordx4 v116, s[36:39], s45 offen offset:0 lds
    v_mfma_f32_16x16x32_bf16 v[88:91], v[52:55], v[172:175], v[88:91]
    ds_read_b64_tr_b16 v[44:45], v17 offset:24576
    v_mfma_f32_16x16x32_bf16 v[88:91], v[48:51], v[164:167], v[88:91]
    ds_read_b64_tr_b16 v[46:47], v17 offset:25600
    buffer_load_dwordx4 v113, s[36:39], s45 offen offset:1024 lds
    v_mfma_f32_16x16x32_bf16 v[92:95], v[56:59], v[164:167], v[92:95]
    ds_read_b64_tr_b16 v[48:49], v18 offset:16384
    v_mfma_f32_16x16x32_bf16 v[92:95], v[60:63], v[172:175], v[92:95]
    ds_read_b64_tr_b16 v[50:51], v18 offset:17408
    v_mfma_f32_16x16x32_bf16 v[76:79], v[60:63], v[168:171], v[76:79]
    ds_read_b64_tr_b16 v[52:53], v18 offset:24576
    v_mfma_f32_16x16x32_bf16 v[76:79], v[56:59], v[160:163], v[76:79]
    ds_read_b64_tr_b16 v[54:55], v18 offset:25600
    s_waitcnt lgkmcnt(4)
    v_mfma_f32_16x16x32_bf16 v[64:67], v[32:35], v[176:179], v[64:67]
    ds_read_b64_tr_b16 v[56:57], v19 offset:16384
    v_mfma_f32_16x16x32_bf16 v[64:67], v[36:39], v[184:187], v[64:67]
    ds_read_b64_tr_b16 v[58:59], v19 offset:17408
    buffer_load_dwordx4 v114, s[36:39], s45 offen offset:2048 lds
    v_mfma_f32_16x16x32_bf16 v[80:83], v[36:39], v[188:191], v[80:83]
    ds_read_b64_tr_b16 v[60:61], v19 offset:24576
    v_mfma_f32_16x16x32_bf16 v[80:83], v[32:35], v[180:183], v[80:83]
    ds_read_b64_tr_b16 v[62:63], v19 offset:25600
    buffer_load_dwordx4 v115, s[36:39], s45 offen offset:3072 lds
    v_add_u32 v16, 4294836224, v16
    v_mfma_f32_16x16x32_bf16 v[84:87], v[40:43], v[180:183], v[84:87]
    ds_read_b64_tr_b16 v[32:33], v16 offset:0
    v_mfma_f32_16x16x32_bf16 v[84:87], v[44:47], v[188:191], v[84:87]
    ds_read_b64_tr_b16 v[34:35], v16 offset:1024
    v_mfma_f32_16x16x32_bf16 v[68:71], v[44:47], v[184:187], v[68:71]
    ds_read_b64_tr_b16 v[36:37], v16 offset:8192
    v_mfma_f32_16x16x32_bf16 v[68:71], v[40:43], v[176:179], v[68:71]
    ds_read_b64_tr_b16 v[38:39], v16 offset:9216
    s_waitcnt lgkmcnt(4)
    v_add_u32 v17, 4294836224, v17
    v_mfma_f32_16x16x32_bf16 v[72:75], v[48:51], v[176:179], v[72:75]
    ds_read_b64_tr_b16 v[40:41], v17 offset:0
    v_mfma_f32_16x16x32_bf16 v[72:75], v[52:55], v[184:187], v[72:75]
    ds_read_b64_tr_b16 v[42:43], v17 offset:1024
    v_mfma_f32_16x16x32_bf16 v[88:91], v[52:55], v[188:191], v[88:91]
    ds_read_b64_tr_b16 v[44:45], v17 offset:8192
    v_mfma_f32_16x16x32_bf16 v[88:91], v[48:51], v[180:183], v[88:91]
    ds_read_b64_tr_b16 v[46:47], v17 offset:9216
    v_add_u32 v18, 4294836224, v18
    v_mfma_f32_16x16x32_bf16 v[92:95], v[56:59], v[180:183], v[92:95]
    s_barrier
    ds_read_b64_tr_b16 v[48:49], v18 offset:0
    v_mfma_f32_16x16x32_bf16 v[92:95], v[60:63], v[188:191], v[92:95]
    ds_read_b64_tr_b16 v[50:51], v18 offset:1024
    s_add_u32 m0, s74, 131072
    s_nop 0
    buffer_load_dwordx4 v116, s[36:39], s46 offen offset:0 lds
    v_mfma_f32_16x16x32_bf16 v[76:79], v[60:63], v[184:187], v[76:79]
    ds_read_b64_tr_b16 v[52:53], v18 offset:8192
    v_mfma_f32_16x16x32_bf16 v[76:79], v[56:59], v[176:179], v[76:79]
    ds_read_b64_tr_b16 v[54:55], v18 offset:9216
    s_waitcnt lgkmcnt(4)
    v_add_u32 v19, 4294836224, v19
    v_mfma_f32_16x16x32_bf16 v[64:67], v[32:35], v[192:195], v[64:67]
    ds_read_b64_tr_b16 v[56:57], v19 offset:0
    v_mfma_f32_16x16x32_bf16 v[64:67], v[36:39], v[200:203], v[64:67]
    ds_read_b64_tr_b16 v[58:59], v19 offset:1024
    buffer_load_dwordx4 v113, s[36:39], s46 offen offset:1024 lds
    v_mfma_f32_16x16x32_bf16 v[80:83], v[36:39], v[204:207], v[80:83]
    ds_read_b64_tr_b16 v[60:61], v19 offset:8192
    v_mfma_f32_16x16x32_bf16 v[80:83], v[32:35], v[196:199], v[80:83]
    ds_read_b64_tr_b16 v[62:63], v19 offset:9216
    v_mfma_f32_16x16x32_bf16 v[84:87], v[40:43], v[196:199], v[84:87]
    ds_read_b64_tr_b16 v[32:33], v16 offset:16384
    v_mfma_f32_16x16x32_bf16 v[84:87], v[44:47], v[204:207], v[84:87]
    ds_read_b64_tr_b16 v[34:35], v16 offset:17408
    v_mfma_f32_16x16x32_bf16 v[68:71], v[44:47], v[200:203], v[68:71]
    ds_read_b64_tr_b16 v[36:37], v16 offset:24576
    v_mfma_f32_16x16x32_bf16 v[68:71], v[40:43], v[192:195], v[68:71]
    ds_read_b64_tr_b16 v[38:39], v16 offset:25600
    s_waitcnt lgkmcnt(4)
    s_cmp_lg_u32 s3, 4
    s_cbranch_scc1 f_yp
    v_and_b32 v20, 15, v0
    v_lshlrev_b32 v20, 4, v20
    s_lshl_b32 s56, s54, 8
    v_add_u32 v20, s56, v20
    s_mov_b32 s62, 4210688
    buffer_load_dword v7, v20, s[28:31], s62 offen sc1
f_yp:
    v_mfma_f32_16x16x32_bf16 v[72:75], v[48:51], v[192:195], v[72:75]
    ds_read_b64_tr_b16 v[40:41], v17 offset:16384
    v_mfma_f32_16x16x32_bf16 v[72:75], v[52:55], v[200:203], v[72:75]
    ds_read_b64_tr_b16 v[42:43], v17 offset:17408
    buffer_load_dwordx4 v114, s[36:39], s46 offen offset:2048 lds
    v_mfma_f32_16x16x32_bf16 v[88:91], v[52:55], v[204:207], v[88:91]
    ds_read_b64_tr_b16 v[44:45], v17 offset:24576
    v_mfma_f32_16x16x32_bf16 v[88:91], v[48:51], v[196:199], v[88:91]
    ds_read_b64_tr_b16 v[46:47], v17 offset:25600
    v_mfma_f32_16x16x32_bf16 v[92:95], v[56:59], v[196:199], v[92:95]
    ds_read_b64_tr_b16 v[48:49], v18 offset:16384
    v_mfma_f32_16x16x32_bf16 v[92:95], v[60:63], v[204:207], v[92:95]
    ds_read_b64_tr_b16 v[50:51], v18 offset:17408
    v_mfma_f32_16x16x32_bf16 v[76:79], v[60:63], v[200:203], v[76:79]
    ds_read_b64_tr_b16 v[52:53], v18 offset:24576
    v_mfma_f32_16x16x32_bf16 v[76:79], v[56:59], v[192:195], v[76:79]
    ds_read_b64_tr_b16 v[54:55], v18 offset:25600
    s_waitcnt lgkmcnt(4)
    v_mfma_f32_16x16x32_bf16 v[64:67], v[32:35], v[208:211], v[64:67]
    ds_read_b64_tr_b16 v[56:57], v19 offset:16384
    v_mfma_f32_16x16x32_bf16 v[64:67], v[36:39], v[216:219], v[64:67]
    ds_read_b64_tr_b16 v[58:59], v19 offset:17408
    buffer_load_dwordx4 v115, s[36:39], s46 offen offset:3072 lds
    v_mfma_f32_16x16x32_bf16 v[80:83], v[36:39], v[220:223], v[80:83]
    ds_read_b64_tr_b16 v[60:61], v19 offset:24576
    v_mfma_f32_16x16x32_bf16 v[80:83], v[32:35], v[212:215], v[80:83]
    ds_read_b64_tr_b16 v[62:63], v19 offset:25600
    v_add_u32 v16, 32768, v16
    v_mfma_f32_16x16x32_bf16 v[84:87], v[40:43], v[212:215], v[84:87]
    ds_read_b64_tr_b16 v[32:33], v16 offset:0
    v_mfma_f32_16x16x32_bf16 v[84:87], v[44:47], v[220:223], v[84:87]
    ds_read_b64_tr_b16 v[34:35], v16 offset:1024
    v_mfma_f32_16x16x32_bf16 v[68:71], v[44:47], v[216:219], v[68:71]
    ds_read_b64_tr_b16 v[36:37], v16 offset:8192
    v_mfma_f32_16x16x32_bf16 v[68:71], v[40:43], v[208:211], v[68:71]
    ds_read_b64_tr_b16 v[38:39], v16 offset:9216
    s_waitcnt lgkmcnt(4)
    v_add_u32 v17, 32768, v17
    v_mfma_f32_16x16x32_bf16 v[72:75], v[48:51], v[208:211], v[72:75]
    ds_read_b64_tr_b16 v[40:41], v17 offset:0
    v_mfma_f32_16x16x32_bf16 v[72:75], v[52:55], v[216:219], v[72:75]
    ds_read_b64_tr_b16 v[42:43], v17 offset:1024
    v_mfma_f32_16x16x32_bf16 v[88:91], v[52:55], v[220:223], v[88:91]
    ds_read_b64_tr_b16 v[44:45], v17 offset:8192
    v_mfma_f32_16x16x32_bf16 v[88:91], v[48:51], v[212:215], v[88:91]
    ds_read_b64_tr_b16 v[46:47], v17 offset:9216
    v_add_u32 v18, 32768, v18
    v_mfma_f32_16x16x32_bf16 v[92:95], v[56:59], v[212:215], v[92:95]
    s_cmp_lg_u32 s3, 4
    s_cbranch_scc1 f_pd3
    s_waitcnt vmcnt(2)
    s_mov_b32 s57, 50000
    s_branch f_pc3
f_pl3:
    s_mov_b32 s62, 4210688
    buffer_load_dword v7, v20, s[28:31], s62 offen sc1
    s_waitcnt vmcnt(0)
f_pc3:
    v_cmp_eq_u32 vcc, s64, v7
    s_cmp_eq_u64 vcc, -1
    s_cbranch_scc1 f_pd3
    s_sleep 4
    s_sub_u32 s57, s57, 1
    s_cmp_lg_u32 s57, 0
    s_cbranch_scc1 f_pl3
f_pd3:
    s_waitcnt vmcnt(4)
    s_barrier
    ds_read_b64_tr_b16 v[48:49], v18 offset:0
    v_mfma_f32_16x16x32_bf16 v[92:95], v[60:63], v[220:223], v[92:95]
    ds_read_b64_tr_b16 v[50:51], v18 offset:1024
    buffer_load_dwordx4 v[128:131], v117, s[28:31], s4 offen sc1
    v_mfma_f32_16x16x32_bf16 v[76:79], v[60:63], v[216:219], v[76:79]
    ds_read_b64_tr_b16 v[52:53], v18 offset:8192
    v_mfma_f32_16x16x32_bf16 v[76:79], v[56:59], v[208:211], v[76:79]
    ds_read_b64_tr_b16 v[54:55], v18 offset:9216
    buffer_load_dwordx4 v[132:135], v118, s[28:31], s4 offen sc1
    s_waitcnt lgkmcnt(4)
    v_add_u32 v19, 32768, v19
    v_mfma_f32_16x16x32_bf16 v[64:67], v[32:35], v[224:227], v[64:67]
    ds_read_b64_tr_b16 v[56:57], v19 offset:0
    v_mfma_f32_16x16x32_bf16 v[64:67], v[36:39], v[232:235], v[64:67]
    ds_read_b64_tr_b16 v[58:59], v19 offset:1024
    buffer_load_dwordx4 v[136:139], v119, s[28:31], s4 offen sc1
    v_mfma_f32_16x16x32_bf16 v[80:83], v[36:39], v[236:239], v[80:83]
    ds_read_b64_tr_b16 v[60:61], v19 offset:8192
    v_mfma_f32_16x16x32_bf16 v[80:83], v[32:35], v[228:231], v[80:83]
    ds_read_b64_tr_b16 v[62:63], v19 offset:9216
    buffer_load_dwordx4 v[140:143], v127, s[28:31], s4 offen sc1
    v_mfma_f32_16x16x32_bf16 v[84:87], v[40:43], v[228:231], v[84:87]
    ds_read_b64_tr_b16 v[32:33], v16 offset:16384
    v_mfma_f32_16x16x32_bf16 v[84:87], v[44:47], v[236:239], v[84:87]
    ds_read_b64_tr_b16 v[34:35], v16 offset:17408
    v_mfma_f32_16x16x32_bf16 v[68:71], v[44:47], v[232:235], v[68:71]
    ds_read_b64_tr_b16 v[36:37], v16 offset:24576
    v_mfma_f32_16x16x32_bf16 v[68:71], v[40:43], v[224:227], v[68:71]
    ds_read_b64_tr_b16 v[38:39], v16 offset:25600
    s_waitcnt lgkmcnt(4)
    v_mfma_f32_16x16x32_bf16 v[72:75], v[48:51], v[224:227], v[72:75]
    ds_read_b64_tr_b16 v[40:41], v17 offset:16384
    v_mfma_f32_16x16x32_bf16 v[72:75], v[52:55], v[232:235], v[72:75]
    ds_read_b64_tr_b16 v[42:43], v17 offset:17408
    buffer_load_dwordx4 v[144:147], v117, s[28:31], s5 offen sc1
    v_mfma_f32_16x16x32_bf16 v[88:91], v[52:55], v[236:239], v[88:91]
    ds_read_b64_tr_b16 v[44:45], v17 offset:24576
    v_mfma_f32_16x16x32_bf16 v[88:91], v[48:51], v[228:231], v[88:91]
    ds_read_b64_tr_b16 v[46:47], v17 offset:25600
    buffer_load_dwordx4 v[148:151], v118, s[28:31], s5 offen sc1
    v_mfma_f32_16x16x32_bf16 v[92:95], v[56:59], v[228:231], v[92:95]
    ds_read_b64_tr_b16 v[48:49], v18 offset:16384
    v_mfma_f32_16x16x32_bf16 v[92:95], v[60:63], v[236:239], v[92:95]
    ds_read_b64_tr_b16 v[50:51], v18 offset:17408
    s_add_u32 m0, s74, 0
    s_nop 0
    buffer_load_dwordx4 v116, s[36:39], s47 offen offset:0 lds
    v_mfma_f32_16x16x32_bf16 v[76:79], v[60:63], v[232:235], v[76:79]
    ds_read_b64_tr_b16 v[52:53], v18 offset:24576
    v_mfma_f32_16x16x32_bf16 v[76:79], v[56:59], v[224:227], v[76:79]
    ds_read_b64_tr_b16 v[54:55], v18 offset:25600
    s_waitcnt lgkmcnt(4)
    v_mfma_f32_16x16x32_bf16 v[64:67], v[32:35], v[240:243], v[64:67]
    ds_read_b64_tr_b16 v[56:57], v19 offset:16384
    v_mfma_f32_16x16x32_bf16 v[64:67], v[36:39], v[248:251], v[64:67]
    ds_read_b64_tr_b16 v[58:59], v19 offset:17408
    buffer_load_dwordx4 v[152:155], v119, s[28:31], s5 offen sc1
    v_mfma_f32_16x16x32_bf16 v[80:83], v[36:39], v[252:255], v[80:83]
    ds_read_b64_tr_b16 v[60:61], v19 offset:24576
    v_mfma_f32_16x16x32_bf16 v[80:83], v[32:35], v[244:247], v[80:83]
    ds_read_b64_tr_b16 v[62:63], v19 offset:25600
    buffer_load_dwordx4 v[156:159], v127, s[28:31], s5 offen sc1
    v_add_u32 v16, 32768, v16
    v_mfma_f32_16x16x32_bf16 v[84:87], v[40:43], v[244:247], v[84:87]
    ds_read_b64_tr_b16 v[32:33], v16 offset:0
    v_mfma_f32_16x16x32_bf16 v[84:87], v[44:47], v[252:255], v[84:87]
    ds_read_b64_tr_b16 v[34:35], v16 offset:1024
    buffer_load_dwordx4 v113, s[36:39], s47 offen offset:1024 lds
    v_mfma_f32_16x16x32_bf16 v[68:71], v[44:47], v[248:251], v[68:71]
    ds_read_b64_tr_b16 v[36:37], v16 offset:8192
    v_mfma_f32_16x16x32_bf16 v[68:71], v[40:43], v[240:243], v[68:71]
    ds_read_b64_tr_b16 v[38:39], v16 offset:9216
    s_waitcnt lgkmcnt(4)
    v_add_u32 v17, 32768, v17
    v_mfma_f32_16x16x32_bf16 v[72:75], v[48:51], v[240:243], v[72:75]
    ds_read_b64_tr_b16 v[40:41], v17 offset:0
    v_mfma_f32_16x16x32_bf16 v[72:75], v[52:55], v[248:251], v[72:75]
    ds_read_b64_tr_b16 v[42:43], v17 offset:1024
    buffer_load_dwordx4 v[160:163], v117, s[28:31], s6 offen sc1
    v_mfma_f32_16x16x32_bf16 v[88:91], v[52:55], v[252:255], v[88:91]
    ds_read_b64_tr_b16 v[44:45], v17 offset:8192
    v_mfma_f32_16x16x32_bf16 v[88:91], v[48:51], v[244:247], v[88:91]
    ds_read_b64_tr_b16 v[46:47], v17 offset:9216
    buffer_load_dwordx4 v[164:167], v118, s[28:31], s6 offen sc1
    v_add_u32 v18, 32768, v18
    v_mfma_f32_16x16x32_bf16 v[92:95], v[56:59], v[244:247], v[92:95]
    ds_read_b64_tr_b16 v[48:49], v18 offset:0
    v_mfma_f32_16x16x32_bf16 v[92:95], v[60:63], v[252:255], v[92:95]
    ds_read_b64_tr_b16 v[50:51], v18 offset:1024
    buffer_load_dwordx4 v114, s[36:39], s47 offen offset:2048 lds
    v_mfma_f32_16x16x32_bf16 v[76:79], v[60:63], v[248:251], v[76:79]
    ds_read_b64_tr_b16 v[52:53], v18 offset:8192
    v_mfma_f32_16x16x32_bf16 v[76:79], v[56:59], v[240:243], v[76:79]
    ds_read_b64_tr_b16 v[54:55], v18 offset:9216
    s_waitcnt lgkmcnt(4) vmcnt(9)
    v_add_u32 v19, 32768, v19
    v_mfma_f32_16x16x32_bf16 v[64:67], v[32:35], v[128:131], v[64:67]
    ds_read_b64_tr_b16 v[56:57], v19 offset:0
    v_mfma_f32_16x16x32_bf16 v[64:67], v[36:39], v[136:139], v[64:67]
    ds_read_b64_tr_b16 v[58:59], v19 offset:1024
    buffer_load_dwordx4 v[168:171], v119, s[28:31], s6 offen sc1
    v_mfma_f32_16x16x32_bf16 v[80:83], v[36:39], v[140:143], v[80:83]
    ds_read_b64_tr_b16 v[60:61], v19 offset:8192
    v_mfma_f32_16x16x32_bf16 v[80:83], v[32:35], v[132:135], v[80:83]
    ds_read_b64_tr_b16 v[62:63], v19 offset:9216
    buffer_load_dwordx4 v[172:175], v127, s[28:31], s6 offen sc1
    v_mfma_f32_16x16x32_bf16 v[84:87], v[40:43], v[132:135], v[84:87]
    ds_read_b64_tr_b16 v[32:33], v16 offset:16384
    v_mfma_f32_16x16x32_bf16 v[84:87], v[44:47], v[140:143], v[84:87]
    ds_read_b64_tr_b16 v[34:35], v16 offset:17408
    buffer_load_dwordx4 v115, s[36:39], s47 offen offset:3072 lds
    v_mfma_f32_16x16x32_bf16 v[68:71], v[44:47], v[136:139], v[68:71]
    ds_read_b64_tr_b16 v[36:37], v16 offset:24576
    v_mfma_f32_16x16x32_bf16 v[68:71], v[40:43], v[128:131], v[68:71]
    ds_read_b64_tr_b16 v[38:39], v16 offset:25600
    s_waitcnt lgkmcnt(4)
    v_mfma_f32_16x16x32_bf16 v[72:75], v[48:51], v[128:131], v[72:75]
    ds_read_b64_tr_b16 v[40:41], v17 offset:16384
    v_mfma_f32_16x16x32_bf16 v[72:75], v[52:55], v[136:139], v[72:75]
    ds_read_b64_tr_b16 v[42:43], v17 offset:17408
    buffer_load_dwordx4 v[176:179], v117, s[28:31], s7 offen sc1
    v_mfma_f32_16x16x32_bf16 v[88:91], v[52:55], v[140:143], v[88:91]
    ds_read_b64_tr_b16 v[44:45], v17 offset:24576
    v_mfma_f32_16x16x32_bf16 v[88:91], v[48:51], v[132:135], v[88:91]
    ds_read_b64_tr_b16 v[46:47], v17 offset:25600
    buffer_load_dwordx4 v[180:183], v118, s[28:31], s7 offen sc1
    v_mfma_f32_16x16x32_bf16 v[92:95], v[56:59], v[132:135], v[92:95]
    ds_read_b64_tr_b16 v[48:49], v18 offset:16384
    v_mfma_f32_16x16x32_bf16 v[92:95], v[60:63], v[140:143], v[92:95]
    ds_read_b64_tr_b16 v[50:51], v18 offset:17408
    v_mfma_f32_16x16x32_bf16 v[76:79], v[60:63], v[136:139], v[76:79]
    ds_read_b64_tr_b16 v[52:53], v18 offset:24576
    v_mfma_f32_16x16x32_bf16 v[76:79], v[56:59], v[128:131], v[76:79]
    ds_read_b64_tr_b16 v[54:55], v18 offset:25600
    s_waitcnt lgkmcnt(4) vmcnt(9)
    v_mfma_f32_16x16x32_bf16 v[64:67], v[32:35], v[144:147], v[64:67]
    ds_read_b64_tr_b16 v[56:57], v19 offset:16384
    v_mfma_f32_16x16x32_bf16 v[64:67], v[36:39], v[152:155], v[64:67]
    ds_read_b64_tr_b16 v[58:59], v19 offset:17408
    buffer_load_dwordx4 v[184:187], v119, s[28:31], s7 offen sc1
    v_mfma_f32_16x16x32_bf16 v[80:83], v[36:39], v[156:159], v[80:83]
    ds_read_b64_tr_b16 v[60:61], v19 offset:24576
    v_mfma_f32_16x16x32_bf16 v[80:83], v[32:35], v[148:151], v[80:83]
    ds_read_b64_tr_b16 v[62:63], v19 offset:25600
    buffer_load_dwordx4 v[188:191], v127, s[28:31], s7 offen sc1
    v_add_u32 v16, 32768, v16
    v_mfma_f32_16x16x32_bf16 v[84:87], v[40:43], v[148:151], v[84:87]
    ds_read_b64_tr_b16 v[32:33], v16 offset:0
    v_mfma_f32_16x16x32_bf16 v[84:87], v[44:47], v[156:159], v[84:87]
    ds_read_b64_tr_b16 v[34:35], v16 offset:1024
    v_mfma_f32_16x16x32_bf16 v[68:71], v[44:47], v[152:155], v[68:71]
    ds_read_b64_tr_b16 v[36:37], v16 offset:8192
    v_mfma_f32_16x16x32_bf16 v[68:71], v[40:43], v[144:147], v[68:71]
    ds_read_b64_tr_b16 v[38:39], v16 offset:9216
    s_waitcnt lgkmcnt(4)
    v_add_u32 v17, 32768, v17
    v_mfma_f32_16x16x32_bf16 v[72:75], v[48:51], v[144:147], v[72:75]
    ds_read_b64_tr_b16 v[40:41], v17 offset:0
    v_mfma_f32_16x16x32_bf16 v[72:75], v[52:55], v[152:155], v[72:75]
    ds_read_b64_tr_b16 v[42:43], v17 offset:1024
    buffer_load_dwordx4 v[192:195], v117, s[28:31], s8 offen sc1
    v_mfma_f32_16x16x32_bf16 v[88:91], v[52:55], v[156:159], v[88:91]
    ds_read_b64_tr_b16 v[44:45], v17 offset:8192
    v_mfma_f32_16x16x32_bf16 v[88:91], v[48:51], v[148:151], v[88:91]
    ds_read_b64_tr_b16 v[46:47], v17 offset:9216
    buffer_load_dwordx4 v[196:199], v118, s[28:31], s8 offen sc1
    v_add_u32 v18, 32768, v18
    v_mfma_f32_16x16x32_bf16 v[92:95], v[56:59], v[148:151], v[92:95]
    ds_read_b64_tr_b16 v[48:49], v18 offset:0
    v_mfma_f32_16x16x32_bf16 v[92:95], v[60:63], v[156:159], v[92:95]
    ds_read_b64_tr_b16 v[50:51], v18 offset:1024
    v_mfma_f32_16x16x32_bf16 v[76:79], v[60:63], v[152:155], v[76:79]
    ds_read_b64_tr_b16 v[52:53], v18 offset:8192
    v_mfma_f32_16x16x32_bf16 v[76:79], v[56:59], v[144:147], v[76:79]
    ds_read_b64_tr_b16 v[54:55], v18 offset:9216
    s_waitcnt lgkmcnt(4) vmcnt(7)
    v_add_u32 v19, 32768, v19
    v_mfma_f32_16x16x32_bf16 v[64:67], v[32:35], v[160:163], v[64:67]
    ds_read_b64_tr_b16 v[56:57], v19 offset:0
    v_mfma_f32_16x16x32_bf16 v[64:67], v[36:39], v[168:171], v[64:67]
    ds_read_b64_tr_b16 v[58:59], v19 offset:1024
    buffer_load_dwordx4 v[200:203], v119, s[28:31], s8 offen sc1
    v_mfma_f32_16x16x32_bf16 v[80:83], v[36:39], v[172:175], v[80:83]
    ds_read_b64_tr_b16 v[60:61], v19 offset:8192
    v_mfma_f32_16x16x32_bf16 v[80:83], v[32:35], v[164:167], v[80:83]
    ds_read_b64_tr_b16 v[62:63], v19 offset:9216
    buffer_load_dwordx4 v[204:207], v127, s[28:31], s8 offen sc1
    v_mfma_f32_16x16x32_bf16 v[84:87], v[40:43], v[164:167], v[84:87]
    ds_read_b64_tr_b16 v[32:33], v16 offset:16384
    v_mfma_f32_16x16x32_bf16 v[84:87], v[44:47], v[172:175], v[84:87]
    ds_read_b64_tr_b16 v[34:35], v16 offset:17408
    v_mfma_f32_16x16x32_bf16 v[68:71], v[44:47], v[168:171], v[68:71]
    ds_read_b64_tr_b16 v[36:37], v16 offset:24576
    v_mfma_f32_16x16x32_bf16 v[68:71], v[40:43], v[160:163], v[68:71]
    ds_read_b64_tr_b16 v[38:39], v16 offset:25600
    s_waitcnt lgkmcnt(4)
    v_mfma_f32_16x16x32_bf16 v[72:75], v[48:51], v[160:163], v[72:75]
    ds_read_b64_tr_b16 v[40:41], v17 offset:16384
    v_mfma_f32_16x16x32_bf16 v[72:75], v[52:55], v[168:171], v[72:75]
    ds_read_b64_tr_b16 v[42:43], v17 offset:17408
    v_mfma_f32_16x16x32_bf16 v[88:91], v[52:55], v[172:175], v[88:91]
    ds_read_b64_tr_b16 v[44:45], v17 offset:24576
    v_mfma_f32_16x16x32_bf16 v[88:91], v[48:51], v[164:167], v[88:91]
    ds_read_b64_tr_b16 v[46:47], v17 offset:25600
    v_mfma_f32_16x16x32_bf16 v[92:95], v[56:59], v[164:167], v[92:95]
    s_waitcnt vmcnt(8)
    s_barrier
    ds_read_b64_tr_b16 v[48:49], v18 offset:16384
    v_mfma_f32_16x16x32_bf16 v[92:95], v[60:63], v[172:175], v[92:95]
    ds_read_b64_tr_b16 v[50:51], v18 offset:17408
    buffer_load_dwordx4 v[208:211], v117, s[28:31], s9 offen sc1
    v_mfma_f32_16x16x32_bf16 v[76:79], v[60:63], v[168:171], v[76:79]
    ds_read_b64_tr_b16 v[52:53], v18 offset:24576
    v_mfma_f32_16x16x32_bf16 v[76:79], v[56:59], v[160:163], v[76:79]
    ds_read_b64_tr_b16 v[54:55], v18 offset:25600
    buffer_load_dwordx4 v[212:215], v118, s[28:31], s9 offen sc1
    s_waitcnt lgkmcnt(4) vmcnt(6)
    v_mfma_f32_16x16x32_bf16 v[64:67], v[32:35], v[176:179], v[64:67]
    ds_read_b64_tr_b16 v[56:57], v19 offset:16384
    v_mfma_f32_16x16x32_bf16 v[64:67], v[36:39], v[184:187], v[64:67]
    ds_read_b64_tr_b16 v[58:59], v19 offset:17408
    buffer_load_dwordx4 v[216:219], v119, s[28:31], s9 offen sc1
    v_mfma_f32_16x16x32_bf16 v[80:83], v[36:39], v[188:191], v[80:83]
    ds_read_b64_tr_b16 v[60:61], v19 offset:24576
    v_mfma_f32_16x16x32_bf16 v[80:83], v[32:35], v[180:183], v[80:83]
    ds_read_b64_tr_b16 v[62:63], v19 offset:25600
    buffer_load_dwordx4 v[220:223], v127, s[28:31], s9 offen sc1
    v_add_u32 v16, 32768, v16
    v_mfma_f32_16x16x32_bf16 v[84:87], v[40:43], v[180:183], v[84:87]
    ds_read_b64_tr_b16 v[32:33], v16 offset:0
    v_mfma_f32_16x16x32_bf16 v[84:87], v[44:47], v[188:191], v[84:87]
    ds_read_b64_tr_b16 v[34:35], v16 offset:1024
    v_mfma_f32_16x16x32_bf16 v[68:71], v[44:47], v[184:187], v[68:71]
    ds_read_b64_tr_b16 v[36:37], v16 offset:8192
    v_mfma_f32_16x16x32_bf16 v[68:71], v[40:43], v[176:179], v[68:71]
    ds_read_b64_tr_b16 v[38:39], v16 offset:9216
    s_waitcnt lgkmcnt(4)
    v_add_u32 v17, 32768, v17
    v_mfma_f32_16x16x32_bf16 v[72:75], v[48:51], v[176:179], v[72:75]
    ds_read_b64_tr_b16 v[40:41], v17 offset:0
    v_mfma_f32_16x16x32_bf16 v[72:75], v[52:55], v[184:187], v[72:75]
    ds_read_b64_tr_b16 v[42:43], v17 offset:1024
    buffer_load_dwordx4 v[224:227], v117, s[28:31], s10 offen sc1
    v_mfma_f32_16x16x32_bf16 v[88:91], v[52:55], v[188:191], v[88:91]
    ds_read_b64_tr_b16 v[44:45], v17 offset:8192
    v_mfma_f32_16x16x32_bf16 v[88:91], v[48:51], v[180:183], v[88:91]
    ds_read_b64_tr_b16 v[46:47], v17 offset:9216
    buffer_load_dwordx4 v[228:231], v118, s[28:31], s10 offen sc1
    v_add_u32 v18, 32768, v18
    v_mfma_f32_16x16x32_bf16 v[92:95], v[56:59], v[180:183], v[92:95]
    ds_read_b64_tr_b16 v[48:49], v18 offset:0
    v_mfma_f32_16x16x32_bf16 v[92:95], v[60:63], v[188:191], v[92:95]
    ds_read_b64_tr_b16 v[50:51], v18 offset:1024
    v_mfma_f32_16x16x32_bf16 v[76:79], v[60:63], v[184:187], v[76:79]
    ds_read_b64_tr_b16 v[52:53], v18 offset:8192
    v_mfma_f32_16x16x32_bf16 v[76:79], v[56:59], v[176:179], v[76:79]
    ds_read_b64_tr_b16 v[54:55], v18 offset:9216
    s_waitcnt lgkmcnt(4) vmcnt(6)
    v_add_u32 v19, 32768, v19
    v_mfma_f32_16x16x32_bf16 v[64:67], v[32:35], v[192:195], v[64:67]
    ds_read_b64_tr_b16 v[56:57], v19 offset:0
    v_mfma_f32_16x16x32_bf16 v[64:67], v[36:39], v[200:203], v[64:67]
    ds_read_b64_tr_b16 v[58:59], v19 offset:1024
    buffer_load_dwordx4 v[232:235], v119, s[28:31], s10 offen sc1
    v_mfma_f32_16x16x32_bf16 v[80:83], v[36:39], v[204:207], v[80:83]
    ds_read_b64_tr_b16 v[60:61], v19 offset:8192
    v_mfma_f32_16x16x32_bf16 v[80:83], v[32:35], v[196:199], v[80:83]
    ds_read_b64_tr_b16 v[62:63], v19 offset:9216
    buffer_load_dwordx4 v[236:239], v127, s[28:31], s10 offen sc1
    v_mfma_f32_16x16x32_bf16 v[84:87], v[40:43], v[196:199], v[84:87]
    ds_read_b64_tr_b16 v[32:33], v16 offset:16384
    v_mfma_f32_16x16x32_bf16 v[84:87], v[44:47], v[204:207], v[84:87]
    ds_read_b64_tr_b16 v[34:35], v16 offset:17408
    v_mfma_f32_16x16x32_bf16 v[68:71], v[44:47], v[200:203], v[68:71]
    ds_read_b64_tr_b16 v[36:37], v16 offset:24576
    v_mfma_f32_16x16x32_bf16 v[68:71], v[40:43], v[192:195], v[68:71]
    ds_read_b64_tr_b16 v[38:39], v16 offset:25600
    s_waitcnt lgkmcnt(4)
    v_mfma_f32_16x16x32_bf16 v[72:75], v[48:51], v[192:195], v[72:75]
    ds_read_b64_tr_b16 v[40:41], v17 offset:16384
    v_mfma_f32_16x16x32_bf16 v[72:75], v[52:55], v[200:203], v[72:75]
    ds_read_b64_tr_b16 v[42:43], v17 offset:17408
    buffer_load_dwordx4 v[240:243], v117, s[28:31], s11 offen sc1
    v_mfma_f32_16x16x32_bf16 v[88:91], v[52:55], v[204:207], v[88:91]
    ds_read_b64_tr_b16 v[44:45], v17 offset:24576
    v_mfma_f32_16x16x32_bf16 v[88:91], v[48:51], v[196:199], v[88:91]
    ds_read_b64_tr_b16 v[46:47], v17 offset:25600
    buffer_load_dwordx4 v[244:247], v118, s[28:31], s11 offen sc1
    v_mfma_f32_16x16x32_bf16 v[92:95], v[56:59], v[196:199], v[92:95]
    ds_read_b64_tr_b16 v[48:49], v18 offset:16384
    v_mfma_f32_16x16x32_bf16 v[92:95], v[60:63], v[204:207], v[92:95]
    ds_read_b64_tr_b16 v[50:51], v18 offset:17408
    v_mfma_f32_16x16x32_bf16 v[76:79], v[60:63], v[200:203], v[76:79]
    ds_read_b64_tr_b16 v[52:53], v18 offset:24576
    v_mfma_f32_16x16x32_bf16 v[76:79], v[56:59], v[192:195], v[76:79]
    ds_read_b64_tr_b16 v[54:55], v18 offset:25600
    s_waitcnt lgkmcnt(4) vmcnt(6)
    v_mfma_f32_16x16x32_bf16 v[64:67], v[32:35], v[208:211], v[64:67]
    ds_read_b64_tr_b16 v[56:57], v19 offset:16384
    v_mfma_f32_16x16x32_bf16 v[64:67], v[36:39], v[216:219], v[64:67]
    ds_read_b64_tr_b16 v[58:59], v19 offset:17408
    buffer_load_dwordx4 v[248:251], v119, s[28:31], s11 offen sc1
    v_mfma_f32_16x16x32_bf16 v[80:83], v[36:39], v[220:223], v[80:83]
    ds_read_b64_tr_b16 v[60:61], v19 offset:24576
    v_mfma_f32_16x16x32_bf16 v[80:83], v[32:35], v[212:215], v[80:83]
    ds_read_b64_tr_b16 v[62:63], v19 offset:25600
    buffer_load_dwordx4 v[252:255], v127, s[28:31], s11 offen sc1
    v_add_u32 v16, 4294836224, v16
    v_mfma_f32_16x16x32_bf16 v[84:87], v[40:43], v[212:215], v[84:87]
    ds_read_b64_tr_b16 v[32:33], v16 offset:0
    v_mfma_f32_16x16x32_bf16 v[84:87], v[44:47], v[220:223], v[84:87]
    ds_read_b64_tr_b16 v[34:35], v16 offset:1024
    v_mfma_f32_16x16x32_bf16 v[68:71], v[44:47], v[216:219], v[68:71]
    ds_read_b64_tr_b16 v[36:37], v16 offset:8192
    v_mfma_f32_16x16x32_bf16 v[68:71], v[40:43], v[208:211], v[68:71]
    ds_read_b64_tr_b16 v[38:39], v16 offset:9216
    s_waitcnt lgkmcnt(4)
    v_add_u32 v17, 4294836224, v17
    v_mfma_f32_16x16x32_bf16 v[72:75], v[48:51], v[208:211], v[72:75]
    ds_read_b64_tr_b16 v[40:41], v17 offset:0
    v_mfma_f32_16x16x32_bf16 v[72:75], v[52:55], v[216:219], v[72:75]
    ds_read_b64_tr_b16 v[42:43], v17 offset:1024
    v_mfma_f32_16x16x32_bf16 v[88:91], v[52:55], v[220:223], v[88:91]
    ds_read_b64_tr_b16 v[44:45], v17 offset:8192
    v_mfma_f32_16x16x32_bf16 v[88:91], v[48:51], v[212:215], v[88:91]
    ds_read_b64_tr_b16 v[46:47], v17 offset:9216
    v_add_u32 v18, 4294836224, v18
    v_mfma_f32_16x16x32_bf16 v[92:95], v[56:59], v[212:215], v[92:95]
    ds_read_b64_tr_b16 v[48:49], v18 offset:0
    v_mfma_f32_16x16x32_bf16 v[92:95], v[60:63], v[220:223], v[92:95]
    ds_read_b64_tr_b16 v[50:51], v18 offset:1024
    v_mfma_f32_16x16x32_bf16 v[76:79], v[60:63], v[216:219], v[76:79]
    ds_read_b64_tr_b16 v[52:53], v18 offset:8192
    v_mfma_f32_16x16x32_bf16 v[76:79], v[56:59], v[208:211], v[76:79]
    ds_read_b64_tr_b16 v[54:55], v18 offset:9216
    s_waitcnt lgkmcnt(4) vmcnt(4)
    v_add_u32 v19, 4294836224, v19
    v_mfma_f32_16x16x32_bf16 v[64:67], v[32:35], v[224:227], v[64:67]
    ds_read_b64_tr_b16 v[56:57], v19 offset:0
    v_mfma_f32_16x16x32_bf16 v[64:67], v[36:39], v[232:235], v[64:67]
    ds_read_b64_tr_b16 v[58:59], v19 offset:1024
    v_mfma_f32_16x16x32_bf16 v[80:83], v[36:39], v[236:239], v[80:83]
    ds_read_b64_tr_b16 v[60:61], v19 offset:8192
    v_mfma_f32_16x16x32_bf16 v[80:83], v[32:35], v[228:231], v[80:83]
    ds_read_b64_tr_b16 v[62:63], v19 offset:9216
    v_mfma_f32_16x16x32_bf16 v[84:87], v[40:43], v[228:231], v[84:87]
    ds_read_b64_tr_b16 v[32:33], v16 offset:16384
    v_mfma_f32_16x16x32_bf16 v[84:87], v[44:47], v[236:239], v[84:87]
    ds_read_b64_tr_b16 v[34:35], v16 offset:17408
    v_mfma_f32_16x16x32_bf16 v[68:71], v[44:47], v[232:235], v[68:71]
    ds_read_b64_tr_b16 v[36:37], v16 offset:24576
    v_mfma_f32_16x16x32_bf16 v[68:71], v[40:43], v[224:227], v[68:71]
    ds_read_b64_tr_b16 v[38:39], v16 offset:25600
    s_waitcnt lgkmcnt(4)
    v_mfma_f32_16x16x32_bf16 v[72:75], v[48:51], v[224:227], v[72:75]
    ds_read_b64_tr_b16 v[40:41], v17 offset:16384
    v_mfma_f32_16x16x32_bf16 v[72:75], v[52:55], v[232:235], v[72:75]
    ds_read_b64_tr_b16 v[42:43], v17 offset:17408
    v_mfma_f32_16x16x32_bf16 v[88:91], v[52:55], v[236:239], v[88:91]
    ds_read_b64_tr_b16 v[44:45], v17 offset:24576
    v_mfma_f32_16x16x32_bf16 v[88:91], v[48:51], v[228:231], v[88:91]
    ds_read_b64_tr_b16 v[46:47], v17 offset:25600
    v_mfma_f32_16x16x32_bf16 v[92:95], v[56:59], v[228:231], v[92:95]
    ds_read_b64_tr_b16 v[48:49], v18 offset:16384
    v_mfma_f32_16x16x32_bf16 v[92:95], v[60:63], v[236:239], v[92:95]
    ds_read_b64_tr_b16 v[50:51], v18 offset:17408
    v_mfma_f32_16x16x32_bf16 v[76:79], v[60:63], v[232:235], v[76:79]
    ds_read_b64_tr_b16 v[52:53], v18 offset:24576
    v_mfma_f32_16x16x32_bf16 v[76:79], v[56:59], v[224:227], v[76:79]
    ds_read_b64_tr_b16 v[54:55], v18 offset:25600
    s_waitcnt lgkmcnt(4) vmcnt(0)
    v_mfma_f32_16x16x32_bf16 v[64:67], v[32:35], v[240:243], v[64:67]
    ds_read_b64_tr_b16 v[56:57], v19 offset:16384
    v_mfma_f32_16x16x32_bf16 v[64:67], v[36:39], v[248:251], v[64:67]
    ds_read_b64_tr_b16 v[58:59], v19 offset:17408
    v_mfma_f32_16x16x32_bf16 v[80:83], v[36:39], v[252:255], v[80:83]
    ds_read_b64_tr_b16 v[60:61], v19 offset:24576
    v_mfma_f32_16x16x32_bf16 v[80:83], v[32:35], v[244:247], v[80:83]
    ds_read_b64_tr_b16 v[62:63], v19 offset:25600
    v_mfma_f32_16x16x32_bf16 v[84:87], v[40:43], v[244:247], v[84:87]
    v_mfma_f32_16x16x32_bf16 v[84:87], v[44:47], v[252:255], v[84:87]
    v_mfma_f32_16x16x32_bf16 v[68:71], v[44:47], v[248:251], v[68:71]
    v_mfma_f32_16x16x32_bf16 v[68:71], v[40:43], v[240:243], v[68:71]
    s_waitcnt lgkmcnt(0)
    v_mfma_f32_16x16x32_bf16 v[72:75], v[48:51], v[240:243], v[72:75]
    v_mfma_f32_16x16x32_bf16 v[72:75], v[52:55], v[248:251], v[72:75]
    v_mfma_f32_16x16x32_bf16 v[88:91], v[52:55], v[252:255], v[88:91]
    v_mfma_f32_16x16x32_bf16 v[88:91], v[48:51], v[244:247], v[88:91]
    v_mfma_f32_16x16x32_bf16 v[92:95], v[56:59], v[244:247], v[92:95]
    v_mfma_f32_16x16x32_bf16 v[92:95], v[60:63], v[252:255], v[92:95]
    v_mfma_f32_16x16x32_bf16 v[76:79], v[60:63], v[248:251], v[76:79]
    v_mfma_f32_16x16x32_bf16 v[76:79], v[56:59], v[240:243], v[76:79]
    s_nop 1
    s_mov_b32 s36, s22
    s_mov_b32 s37, s23
    s_mov_b32 s38, 4194304
    s_mov_b32 s39, 0x20000
    ds_write_b128 v124, v[80:83] offset:32768
    ds_write_b128 v124, v[84:87] offset:33792
    ds_write_b128 v124, v[88:91] offset:34816
    ds_write_b128 v124, v[92:95] offset:35840
    s_waitcnt lgkmcnt(0)
    s_barrier
    ds_read_b128 v[32:35], v125 offset:32768
    ds_read_b128 v[36:39], v125 offset:33792
    ds_read_b128 v[40:43], v125 offset:34816
    ds_read_b128 v[44:47], v125 offset:35840
    s_waitcnt lgkmcnt(2)
    v_pk_add_f32 v[64:65], v[64:65], v[32:33]
    v_pk_add_f32 v[66:67], v[66:67], v[34:35]
    v_pk_add_f32 v[68:69], v[68:69], v[36:37]
    v_pk_add_f32 v[70:71], v[70:71], v[38:39]
    v_cvt_pk_bf16_f32 v48, v64, v65
    v_cvt_pk_bf16_f32 v49, v66, v67
    v_cvt_pk_bf16_f32 v50, v68, v69
    v_cvt_pk_bf16_f32 v51, v70, v71
    s_nop 0
    v_permlane16_swap_b32 v48, v50
    v_permlane16_swap_b32 v49, v51
    buffer_store_dwordx4 v[48:51], v126, s[36:39], s20 offen offset:0
    s_waitcnt lgkmcnt(0)
    v_pk_add_f32 v[72:73], v[72:73], v[40:41]
    v_pk_add_f32 v[74:75], v[74:75], v[42:43]
    v_pk_add_f32 v[76:77], v[76:77], v[44:45]
    v_pk_add_f32 v[78:79], v[78:79], v[46:47]
    v_cvt_pk_bf16_f32 v52, v72, v73
    v_cvt_pk_bf16_f32 v53, v74, v75
    v_cvt_pk_bf16_f32 v54, v76, v77
    v_cvt_pk_bf16_f32 v55, v78, v79
    s_nop 0
    v_permlane16_swap_b32 v52, v54
    v_permlane16_swap_b32 v53, v55
    buffer_store_dwordx4 v[52:55], v126, s[36:39], s20 offen offset:64
f_end:
f_end2:
    s_endpgm
f_compute:
    v_and_b32 v8, 15, v0
    v_lshrrev_b32 v9, 4, v0
    v_bfe_u32 v10, v0, 1, 3
    s_and_b32 s56, s3, 1
    s_lshl_b32 s56, s56, 13
    v_xor_b32 v11, v9, v10
    v_lshlrev_b32 v11, 4, v11
    v_lshl_add_u32 v11, v8, 7, v11
    v_add_u32 v16, s56, v11
    v_xor_b32 v17, 64, v16
    v_bfe_u32 v12, v0, 2, 2
    v_and_b32 v13, 3, v0
    v_lshl_add_u32 v14, v9, 3, v12
    v_lshlrev_b32 v14, 7, v14
    v_lshl_add_u32 v14, v13, 3, v14
    v_bfe_u32 v15, v0, 3, 2
    s_and_b32 s56, s3, 2
    v_xor_b32 v15, s56, v15
    v_lshl_add_u32 v14, v15, 5, v14
    v_add_u32 v18, 16384, v14
    v_xor_b32 v19, 32, v18
    v_and_b32 v8, 0x33, v0
    v_bfe_u32 v9, v0, 2, 1
    v_bfe_u32 v10, v0, 3, 1
    v_lshl_or_b32 v8, v9, 3, v8
    v_lshl_or_b32 v8, v10, 2, v8
    v_lshlrev_b32 v20, 4, v8
    s_waitcnt lgkmcnt(0)
    s_mov_b32 s28, s26
    s_mov_b32 s29, s27
    s_mov_b32 s30, 26214400
    s_mov_b32 s31, 0x20000
    s_mov_b32 s32, s24
    s_mov_b32 s33, s25
    s_mov_b32 s34, 256
    s_mov_b32 s35, 0x20000
    v_mov_b32 v21, 0
    s_or_b32 s56, s2, s3
    s_cmp_lg_u32 s56, 0
    s_cbranch_scc1 f_ntag
    s_memrealtime s[56:57]
    s_waitcnt lgkmcnt(0)
    s_mul_i32 s57, s57, 0x9e3779b1
    s_xor_b32 s56, s56, s57
    s_or_b32 s56, s56, 1
    v_mov_b32 v22, s56
    buffer_store_dword v22, v21, s[32:35], 0 offen sc1
f_ntag:
    v_mov_b32 v24, 0
    v_mov_b32 v25, 0
    v_mov_b32 v26, 0
    v_mov_b32 v27, 0
f_sets:
    s_and_b32 s54, s50, 3
    s_lshl_b32 s54, s54, 2
    s_and_b32 s56, s51, 3
    s_add_u32 s54, s54, s56
    s_lshl_b32 s77, s56, 19
    s_lshr_b32 s55, s50, 2
    s_lshl_b32 s55, s55, 3
    s_lshr_b32 s56, s51, 2
    s_add_u32 s55, s55, s56
    s_and_b32 s56, s3, 1
    s_lshl_b32 s56, s56, 1
    s_lshr_b32 s25, s3, 2
    s_add_u32 s56, s56, s25
    s_lshl_b32 s79, s56, 12
    s_lshl_b32 s52, s48, 2
    s_add_u32 s26, s52, s25
    s_add_u32 s52, s52, s56
    s_bfe_u32 s56, s3, 0x10001
    s_mul_i32 s57, s56, 49152
    s_add_u32 s79, s79, s57
    s_lshl_b32 s53, s49, 1
    s_add_u32 s53, s53, s56
    s_add_u32 s56, s53, 2
    s_and_b32 s56, s56, 7
    s_and_b32 s57, s53, 24
    s_or_b32 s65, s56, s57
    s_lshl_b32 s74, s3, 12
    s_lshl_b32 s75, s3, 10
    s_sub_i32 s76, 8, s52
    s_cmp_gt_i32 s76, 0
    s_cselect_b32 s16, 0, 1.0
    s_cmp_gt_i32 s76, 1
    s_cselect_b32 s17, 4048155338, 0
    s_lshr_b32 s57, s65, 1
    s_lshl_b32 s57, s57, 19
    s_and_b32 s27, s3, 3
    s_lshl_b32 s56, s27, 10
    s_add_u32 s57, s57, s56
    s_add_u32 s57, s57, 8388608
    s_lshl_b32 s56, s26, 12
    s_add_u32 s56, s56, s57
    s_sub_u32 s56, s56, 0x8000
    s_max_u32 s80, s56, s57
    s_addk_i32 s56, 0x2000
    s_max_u32 s81, s56, s57
    s_addk_i32 s56, 0x2000
    s_max_u32 s82, s56, s57
    s_addk_i32 s56, 0x2000
    s_max_u32 s83, s56, s57
    s_addk_i32 s56, 0x2000
    s_max_u32 s84, s56, s57
    s_addk_i32 s56, 0x2000
    s_max_u32 s85, s56, s57
    s_lshl_b32 s56, s54, 2
    s_add_u32 s56, s56, s27
    s_lshl_b32 s20, s56, 1
    s_add_u32 s20, s20, s25
    s_lshl_b32 s20, s20, 15
    s_lshl_b32 s57, s55, 7
    s_add_u32 s20, s20, s57
    s_lshl_b32 s44, s3, 16
    s_add_u32 s44, s44, s57
    s_add_u32 s77, s77, s44
    s_add_u32 s45, s44, 0x80000
    s_add_u32 s46, s44, 0x100000
    s_add_u32 s47, s44, 0x180000
    s_lshl_b32 s56, s56, 17
    s_lshl_b32 s57, s25, 11
    s_add_u32 s56, s56, s57
    s_add_u32 s4, s56, 17891328
    s_movk_i32 s57, 0x2000
    s_add_u32 s5, s4, s57
    s_add_u32 s6, s5, s57
    s_add_u32 s7, s6, s57
    s_add_u32 s8, s7, s57
    s_add_u32 s9, s8, s57
    s_add_u32 s10, s9, s57
    s_add_u32 s11, s10, s57
    s_lshl_b32 s78, s52, 7
    s_add_u32 s78, s78, 17039360
    s_lshl_b32 s56, s52, 17
    s_add_u32 s56, s56, 17825792
    s_lshl_b32 s21, s53, 11
    s_add_u32 s21, s21, s56
    s_lshl_b32 s24, s65, 11
    s_add_u32 s24, s24, s56
    s_add_u32 s24, s24, 0x10000
    s_lshl_b32 s25, s25, 10
    s_cmp_ge_u32 s3, 4
    s_cbranch_scc1 f_sets_r
    v_mfma_f32_32x32x16_bf16 v[128:143], v[24:27], v[24:27], 0
    v_mfma_f32_32x32x16_bf16 v[144:159], v[24:27], v[24:27], 0
    v_mfma_f32_32x32x16_bf16 v[160:175], v[24:27], v[24:27], 0
    v_mfma_f32_32x32x16_bf16 v[176:191], v[24:27], v[24:27], 0
    v_mfma_f32_32x32x16_bf16 v[192:207], v[24:27], v[24:27], 0
    v_mfma_f32_32x32x16_bf16 v[208:223], v[24:27], v[24:27], 0
    v_mfma_f32_32x32x16_bf16 v[224:239], v[24:27], v[24:27], 0
    v_mfma_f32_32x32x16_bf16 v[240:255], v[24:27], v[24:27], 0
f_setv:
    v_and_b32 v12, 31, v0
    v_lshrrev_b32 v4, 5, v0
    v_lshlrev_b32 v4, 3, v4
    v_sub_u32 v6, v12, v4
    v_mov_b32 v4, 4048155338
    v_subrev_u32 v112, 0, v6
    v_subrev_u32 v113, 1, v6
    v_subrev_u32 v114, 2, v6
    v_subrev_u32 v115, 3, v6
    v_subrev_u32 v116, 4, v6
    v_subrev_u32 v117, 5, v6
    v_subrev_u32 v118, 6, v6
    v_subrev_u32 v119, 7, v6
    v_subrev_u32 v120, 16, v6
    v_subrev_u32 v121, 17, v6
    v_subrev_u32 v122, 18, v6
    v_subrev_u32 v123, 19, v6
    v_subrev_u32 v124, 20, v6
    v_subrev_u32 v125, 21, v6
    v_subrev_u32 v126, 22, v6
    v_subrev_u32 v127, 23, v6
    v_ashrrev_i32 v112, 31, v112
    v_ashrrev_i32 v113, 31, v113
    v_ashrrev_i32 v114, 31, v114
    v_ashrrev_i32 v115, 31, v115
    v_ashrrev_i32 v116, 31, v116
    v_ashrrev_i32 v117, 31, v117
    v_ashrrev_i32 v118, 31, v118
    v_ashrrev_i32 v119, 31, v119
    v_ashrrev_i32 v120, 31, v120
    v_ashrrev_i32 v121, 31, v121
    v_ashrrev_i32 v122, 31, v122
    v_ashrrev_i32 v123, 31, v123
    v_ashrrev_i32 v124, 31, v124
    v_ashrrev_i32 v125, 31, v125
    v_ashrrev_i32 v126, 31, v126
    v_ashrrev_i32 v127, 31, v127
    v_and_b32 v112, v4, v112
    v_and_b32 v113, v4, v113
    v_and_b32 v114, v4, v114
    v_and_b32 v115, v4, v115
    v_and_b32 v116, v4, v116
    v_and_b32 v117, v4, v117
    v_and_b32 v118, v4, v118
    v_and_b32 v119, v4, v119
    v_and_b32 v120, v4, v120
    v_and_b32 v121, v4, v121
    v_and_b32 v122, v4, v122
    v_and_b32 v123, v4, v123
    v_and_b32 v124, v4, v124
    v_and_b32 v125, v4, v125
    v_and_b32 v126, v4, v126
    v_and_b32 v127, v4, v127
    v_bfe_i32 v12, v0, 2, 1
    v_mov_b32 v4, 0x3f803f80
    v_and_b32 v10, v4, v12
    v_xor_b32 v8, v4, v10
    v_mov_b32 v9, v8
    v_mov_b32 v11, v10
    v_bfe_i32 v12, v0, 0, 1
    v_and_b32 v12, 0xaaaa, v12
    v_or_b32 v5, 0x4444, v12
    v_add_u32 v2, 0x10000, v1
    v_add_u32 v3, 0x20000, v1
    v_mov_b32 v12, 0
    v_mov_b32 v13, 0
    v_mov_b32 v14, 0
    v_mov_b32 v15, 0
    s_cmp_ge_u32 s3, 4
    s_cbranch_scc1 f_setv_r
    v_mov_b32 v4, v20
    s_mov_b32 s58, 0
    s_mov_b32 s59, 0
    s_mov_b32 s60, 4294918144
    s_mov_b32 s61, 98304
    s_mov_b32 s63, 1048744942
    s_and_b32 s57, s53, 24
    s_add_u32 s92, s53, 4
    s_and_b32 s92, s92, 7
    s_or_b32 s92, s92, s57
    s_lshl_b32 s92, s92, 6
    s_add_u32 s92, s92, s52
    s_lshl_b32 s92, s92, 12
    s_add_u32 s92, s92, 8388608
    s_add_u32 s93, s92, 4096
    s_add_u32 s96, s53, 6
    s_and_b32 s96, s96, 7
    s_or_b32 s96, s96, s57
    s_lshl_b32 s96, s96, 6
    s_add_u32 s96, s96, s52
    s_lshl_b32 s96, s96, 12
    s_add_u32 s96, s96, 8388608
    s_add_u32 s97, s96, 4096
    s_nop 0
    s_barrier
    ds_read_b64_tr_b16 v[64:65], v18 offset:0
    ds_read_b64_tr_b16 v[66:67], v18 offset:512
    ds_read_b64_tr_b16 v[68:69], v18 offset:4096
    ds_read_b64_tr_b16 v[70:71], v18 offset:4608
    ds_read_b64_tr_b16 v[72:73], v19 offset:0
    ds_read_b64_tr_b16 v[74:75], v19 offset:512
    ds_read_b64_tr_b16 v[76:77], v19 offset:4096
    ds_read_b64_tr_b16 v[78:79], v19 offset:4608
    ds_read_b128 v[32:35], v16 offset:0
    ds_read_b128 v[36:39], v17 offset:0
    ds_read_b128 v[40:43], v16 offset:2048
    ds_read_b128 v[44:47], v17 offset:2048
    ds_read_b128 v[48:51], v16 offset:4096
    ds_read_b128 v[52:55], v17 offset:4096
    s_waitcnt lgkmcnt(4)
.p2align 6
f_g1:
    v_mfma_f32_16x16x32_bf16 v[128:131], v[64:67], v[32:35], v[128:131]
    ds_read_b128 v[56:59], v16 offset:6144
    v_mfma_f32_16x16x32_bf16 v[128:131], v[68:71], v[36:39], v[128:131]
    ds_read_b128 v[60:63], v17 offset:6144
    v_mfma_f32_16x16x32_bf16 v[144:147], v[76:79], v[36:39], v[144:147]
    ds_read_b64_tr_b16 v[80:81], v18 offset:8192
    v_mfma_f32_16x16x32_bf16 v[144:147], v[72:75], v[32:35], v[144:147]
    ds_read_b64_tr_b16 v[82:83], v18 offset:8704
    s_waitcnt lgkmcnt(4)
    v_mfma_f32_16x16x32_bf16 v[148:151], v[72:75], v[40:43], v[148:151]
    ds_read_b64_tr_b16 v[84:85], v18 offset:12288
    v_mfma_f32_16x16x32_bf16 v[148:151], v[76:79], v[44:47], v[148:151]
    ds_read_b64_tr_b16 v[86:87], v18 offset:12800
    v_mfma_f32_16x16x32_bf16 v[132:135], v[68:71], v[44:47], v[132:135]
    ds_read_b64_tr_b16 v[88:89], v19 offset:8192
    v_mfma_f32_16x16x32_bf16 v[132:135], v[64:67], v[40:43], v[132:135]
    ds_read_b64_tr_b16 v[90:91], v19 offset:8704
    v_mfma_f32_16x16x32_bf16 v[136:139], v[64:67], v[48:51], v[136:139]
    ds_read_b64_tr_b16 v[92:93], v19 offset:12288
    v_mfma_f32_16x16x32_bf16 v[136:139], v[68:71], v[52:55], v[136:139]
    ds_read_b64_tr_b16 v[94:95], v19 offset:12800
    v_mfma_f32_16x16x32_bf16 v[152:155], v[76:79], v[52:55], v[152:155]
    v_mfma_f32_16x16x32_bf16 v[152:155], v[72:75], v[48:51], v[152:155]
    s_waitcnt lgkmcnt(4)
    v_mfma_f32_16x16x32_bf16 v[156:159], v[72:75], v[56:59], v[156:159]
    s_cmp_eq_u32 s58, 0
    s_cselect_b32 s62, s61, s60
    v_mfma_f32_16x16x32_bf16 v[156:159], v[76:79], v[60:63], v[156:159]
    v_mfma_f32_16x16x32_bf16 v[140:143], v[68:71], v[60:63], v[140:143]
    s_waitcnt lgkmcnt(0)
    v_mfma_f32_16x16x32_bf16 v[140:143], v[64:67], v[56:59], v[140:143]
    v_mfma_f32_16x16x32_bf16 v[160:163], v[80:83], v[32:35], v[160:163]
    ds_read_b64_tr_b16 v[64:65], v18 offset:16384
    v_mfma_f32_16x16x32_bf16 v[160:163], v[84:87], v[36:39], v[160:163]
    ds_read_b64_tr_b16 v[66:67], v18 offset:16896
    v_mfma_f32_16x16x32_bf16 v[176:179], v[92:95], v[36:39], v[176:179]
    ds_read_b64_tr_b16 v[68:69], v18 offset:20480
    v_mfma_f32_16x16x32_bf16 v[176:179], v[88:91], v[32:35], v[176:179]
    ds_read_b64_tr_b16 v[70:71], v18 offset:20992
    v_mfma_f32_16x16x32_bf16 v[180:183], v[88:91], v[40:43], v[180:183]
    ds_read_b64_tr_b16 v[72:73], v19 offset:16384
    v_mfma_f32_16x16x32_bf16 v[180:183], v[92:95], v[44:47], v[180:183]
    ds_read_b64_tr_b16 v[74:75], v19 offset:16896
    v_mfma_f32_16x16x32_bf16 v[164:167], v[84:87], v[44:47], v[164:167]
    ds_read_b64_tr_b16 v[76:77], v19 offset:20480
    v_mfma_f32_16x16x32_bf16 v[164:167], v[80:83], v[40:43], v[164:167]
    ds_read_b64_tr_b16 v[78:79], v19 offset:20992
    v_mfma_f32_16x16x32_bf16 v[168:171], v[80:83], v[48:51], v[168:171]
    v_add_u32 v16, s62, v16
    v_add_u32 v17, s62, v17
    v_mfma_f32_16x16x32_bf16 v[168:171], v[84:87], v[52:55], v[168:171]
    s_add_u32 s58, s58, s62
    s_add_u32 s59, s59, 1
    v_mfma_f32_16x16x32_bf16 v[184:187], v[92:95], v[52:55], v[184:187]
    s_cmp_lg_u32 s59, 15
    v_mfma_f32_16x16x32_bf16 v[184:187], v[88:91], v[48:51], v[184:187]
    v_mfma_f32_16x16x32_bf16 v[188:191], v[88:91], v[56:59], v[188:191]
    v_mfma_f32_16x16x32_bf16 v[188:191], v[92:95], v[60:63], v[188:191]
    v_mfma_f32_16x16x32_bf16 v[172:175], v[84:87], v[60:63], v[172:175]
    s_waitcnt lgkmcnt(0)
    v_mfma_f32_16x16x32_bf16 v[172:175], v[80:83], v[56:59], v[172:175]
    v_mfma_f32_16x16x32_bf16 v[192:195], v[64:67], v[32:35], v[192:195]
    ds_read_b64_tr_b16 v[80:81], v18 offset:24576
    v_mfma_f32_16x16x32_bf16 v[192:195], v[68:71], v[36:39], v[192:195]
    ds_read_b64_tr_b16 v[82:83], v18 offset:25088
    v_mfma_f32_16x16x32_bf16 v[208:211], v[76:79], v[36:39], v[208:211]
    ds_read_b64_tr_b16 v[84:85], v18 offset:28672
    v_mfma_f32_16x16x32_bf16 v[208:211], v[72:75], v[32:35], v[208:211]
    ds_read_b64_tr_b16 v[86:87], v18 offset:29184
    v_mfma_f32_16x16x32_bf16 v[212:215], v[72:75], v[40:43], v[212:215]
    ds_read_b64_tr_b16 v[88:89], v19 offset:24576
    v_mfma_f32_16x16x32_bf16 v[212:215], v[76:79], v[44:47], v[212:215]
    ds_read_b64_tr_b16 v[90:91], v19 offset:25088
    v_mfma_f32_16x16x32_bf16 v[196:199], v[68:71], v[44:47], v[196:199]
    ds_read_b64_tr_b16 v[92:93], v19 offset:28672
    v_mfma_f32_16x16x32_bf16 v[196:199], v[64:67], v[40:43], v[196:199]
    ds_read_b64_tr_b16 v[94:95], v19 offset:29184
    v_mfma_f32_16x16x32_bf16 v[200:203], v[64:67], v[48:51], v[200:203]
    v_add_u32 v18, s62, v18
    v_add_u32 v19, s62, v19
    v_mfma_f32_16x16x32_bf16 v[200:203], v[68:71], v[52:55], v[200:203]
    v_mfma_f32_16x16x32_bf16 v[216:219], v[76:79], v[52:55], v[216:219]
    v_mfma_f32_16x16x32_bf16 v[216:219], v[72:75], v[48:51], v[216:219]
    v_mfma_f32_16x16x32_bf16 v[220:223], v[72:75], v[56:59], v[220:223]
    v_mfma_f32_16x16x32_bf16 v[220:223], v[76:79], v[60:63], v[220:223]
    s_waitcnt lgkmcnt(0)
    s_barrier
    v_mfma_f32_16x16x32_bf16 v[204:207], v[68:71], v[60:63], v[204:207]
    v_mfma_f32_16x16x32_bf16 v[204:207], v[64:67], v[56:59], v[204:207]
    v_mfma_f32_16x16x32_bf16 v[224:227], v[32:35], v[80:83], v[224:227]
    ds_read_b64_tr_b16 v[64:65], v18 offset:0
    v_mfma_f32_16x16x32_bf16 v[224:227], v[36:39], v[84:87], v[224:227]
    ds_read_b64_tr_b16 v[66:67], v18 offset:512
    v_mfma_f32_16x16x32_bf16 v[240:243], v[36:39], v[92:95], v[240:243]
    ds_read_b64_tr_b16 v[68:69], v18 offset:4096
    v_mfma_f32_16x16x32_bf16 v[240:243], v[32:35], v[88:91], v[240:243]
    ds_read_b64_tr_b16 v[70:71], v18 offset:4608
    v_mfma_f32_16x16x32_bf16 v[244:247], v[40:43], v[88:91], v[244:247]
    ds_read_b64_tr_b16 v[72:73], v19 offset:0
    v_mfma_f32_16x16x32_bf16 v[244:247], v[44:47], v[92:95], v[244:247]
    ds_read_b64_tr_b16 v[74:75], v19 offset:512
    v_mfma_f32_16x16x32_bf16 v[228:231], v[44:47], v[84:87], v[228:231]
    ds_read_b64_tr_b16 v[76:77], v19 offset:4096
    v_mfma_f32_16x16x32_bf16 v[228:231], v[40:43], v[80:83], v[228:231]
    ds_read_b64_tr_b16 v[78:79], v19 offset:4608
    v_mfma_f32_16x16x32_bf16 v[232:235], v[48:51], v[80:83], v[232:235]
    ds_read_b128 v[32:35], v16 offset:0
    v_mfma_f32_16x16x32_bf16 v[232:235], v[52:55], v[84:87], v[232:235]
    ds_read_b128 v[36:39], v17 offset:0
    v_mfma_f32_16x16x32_bf16 v[248:251], v[52:55], v[92:95], v[248:251]
    ds_read_b128 v[40:43], v16 offset:2048
    v_mfma_f32_16x16x32_bf16 v[248:251], v[48:51], v[88:91], v[248:251]
    ds_read_b128 v[44:47], v17 offset:2048
    v_mfma_f32_16x16x32_bf16 v[252:255], v[56:59], v[88:91], v[252:255]
    ds_read_b128 v[48:51], v16 offset:4096
    v_mfma_f32_16x16x32_bf16 v[252:255], v[60:63], v[92:95], v[252:255]
    ds_read_b128 v[52:55], v17 offset:4096
    v_mfma_f32_16x16x32_bf16 v[236:239], v[60:63], v[84:87], v[236:239]
    s_waitcnt lgkmcnt(4)
    v_mfma_f32_16x16x32_bf16 v[236:239], v[56:59], v[80:83], v[236:239]
    s_cbranch_scc1 f_g1
    v_mfma_f32_16x16x32_bf16 v[128:131], v[64:67], v[32:35], v[128:131]
    ds_read_b128 v[56:59], v16 offset:6144
    v_mfma_f32_16x16x32_bf16 v[128:131], v[68:71], v[36:39], v[128:131]
    ds_read_b128 v[60:63], v17 offset:6144
    v_mfma_f32_16x16x32_bf16 v[144:147], v[76:79], v[36:39], v[144:147]
    ds_read_b64_tr_b16 v[80:81], v18 offset:8192
    v_mfma_f32_16x16x32_bf16 v[144:147], v[72:75], v[32:35], v[144:147]
    ds_read_b64_tr_b16 v[82:83], v18 offset:8704
    s_waitcnt lgkmcnt(4)
    v_mfma_f32_16x16x32_bf16 v[148:151], v[72:75], v[40:43], v[148:151]
    ds_read_b64_tr_b16 v[84:85], v18 offset:12288
    v_mfma_f32_16x16x32_bf16 v[148:151], v[76:79], v[44:47], v[148:151]
    ds_read_b64_tr_b16 v[86:87], v18 offset:12800
    v_mfma_f32_16x16x32_bf16 v[132:135], v[68:71], v[44:47], v[132:135]
    ds_read_b64_tr_b16 v[88:89], v19 offset:8192
    v_mfma_f32_16x16x32_bf16 v[132:135], v[64:67], v[40:43], v[132:135]
    ds_read_b64_tr_b16 v[90:91], v19 offset:8704
    v_mfma_f32_16x16x32_bf16 v[136:139], v[64:67], v[48:51], v[136:139]
    ds_read_b64_tr_b16 v[92:93], v19 offset:12288
    v_mfma_f32_16x16x32_bf16 v[136:139], v[68:71], v[52:55], v[136:139]
    ds_read_b64_tr_b16 v[94:95], v19 offset:12800
    v_mfma_f32_16x16x32_bf16 v[152:155], v[76:79], v[52:55], v[152:155]
    s_waitcnt vmcnt(0)
    s_add_u32 s56, s74, 147456
    v_mfma_f32_16x16x32_bf16 v[152:155], v[72:75], v[48:51], v[152:155]
    s_waitcnt lgkmcnt(4)
    s_mov_b32 s62, s63
    v_mfma_f32_16x16x32_bf16 v[156:159], v[72:75], v[56:59], v[156:159]
    v_add_u32 v7, s56, v1
    v_mfma_f32_16x16x32_bf16 v[156:159], v[76:79], v[60:63], v[156:159]
    v_cvt_pk_bf16_f32 v24, v128, v129
    v_cvt_pk_bf16_f32 v25, v130, v131
    v_mfma_f32_16x16x32_bf16 v[140:143], v[68:71], v[60:63], v[140:143]
    s_waitcnt lgkmcnt(0)
    v_cvt_pk_bf16_f32 v26, v132, v133
    v_mfma_f32_16x16x32_bf16 v[140:143], v[64:67], v[56:59], v[140:143]
    v_cvt_pk_bf16_f32 v27, v134, v135
    v_cvt_pk_bf16_f32 v28, v144, v145
    v_mfma_f32_16x16x32_bf16 v[160:163], v[80:83], v[32:35], v[160:163]
    ds_read_b64_tr_b16 v[64:65], v18 offset:16384
    v_cvt_pk_bf16_f32 v29, v146, v147
    v_mfma_f32_16x16x32_bf16 v[176:179], v[88:91], v[32:35], v[176:179]
    ds_read_b64_tr_b16 v[66:67], v18 offset:16896
    v_cvt_pk_bf16_f32 v30, v148, v149
    v_mfma_f32_16x16x32_bf16 v[160:163], v[84:87], v[36:39], v[160:163]
    ds_read_b64_tr_b16 v[68:69], v18 offset:20480
    v_cvt_pk_bf16_f32 v31, v150, v151
    v_mfma_f32_16x16x32_bf16 v[176:179], v[92:95], v[36:39], v[176:179]
    ds_read_b64_tr_b16 v[70:71], v18 offset:20992
    v_permlane16_swap_b32 v24, v26
    v_mfma_f32_16x16x32_bf16 v[164:167], v[80:83], v[40:43], v[164:167]
    ds_read_b64_tr_b16 v[72:73], v19 offset:16384
    v_permlane16_swap_b32 v25, v27
    v_mfma_f32_16x16x32_bf16 v[180:183], v[88:91], v[40:43], v[180:183]
    ds_read_b64_tr_b16 v[74:75], v19 offset:16896
    v_permlane16_swap_b32 v28, v30
    v_mfma_f32_16x16x32_bf16 v[164:167], v[84:87], v[44:47], v[164:167]
    ds_read_b64_tr_b16 v[76:77], v19 offset:20480
    v_permlane16_swap_b32 v29, v31
    v_mfma_f32_16x16x32_bf16 v[180:183], v[92:95], v[44:47], v[180:183]
    ds_read_b64_tr_b16 v[78:79], v19 offset:20992
    v_cvt_pk_bf16_f32 v96, v136, v137
    v_mfma_f32_16x16x32_bf16 v[168:171], v[80:83], v[48:51], v[168:171]
    v_cvt_pk_bf16_f32 v97, v138, v139
    v_cvt_pk_bf16_f32 v98, v140, v141
    v_mfma_f32_16x16x32_bf16 v[184:187], v[88:91], v[48:51], v[184:187]
    v_cvt_pk_bf16_f32 v99, v142, v143
    v_cvt_pk_bf16_f32 v100, v152, v153
    v_mfma_f32_16x16x32_bf16 v[168:171], v[84:87], v[52:55], v[168:171]
    v_cvt_pk_bf16_f32 v101, v154, v155
    v_cvt_pk_bf16_f32 v102, v156, v157
    v_mfma_f32_16x16x32_bf16 v[184:187], v[92:95], v[52:55], v[184:187]
    v_cvt_pk_bf16_f32 v103, v158, v159
    v_permlane16_swap_b32 v96, v98
    v_mfma_f32_16x16x32_bf16 v[172:175], v[80:83], v[56:59], v[172:175]
    v_permlane16_swap_b32 v97, v99
    v_mfma_f32_16x16x32_bf16 v[188:191], v[88:91], v[56:59], v[188:191]
    v_permlane16_swap_b32 v100, v102
    v_mfma_f32_16x16x32_bf16 v[172:175], v[84:87], v[60:63], v[172:175]
    s_waitcnt lgkmcnt(0)
    v_permlane16_swap_b32 v101, v103
    v_mfma_f32_16x16x32_bf16 v[188:191], v[92:95], v[60:63], v[188:191]
    ds_write_b128 v7, v[96:99]
    v_mfma_f32_16x16x32_bf16 v[192:195], v[64:67], v[32:35], v[192:195]
    ds_read_b64_tr_b16 v[80:81], v18 offset:24576
    ds_write_b128 v7, v[100:103] offset:1024
    v_mfma_f32_16x16x32_bf16 v[208:211], v[72:75], v[32:35], v[208:211]
    ds_read_b64_tr_b16 v[82:83], v18 offset:25088
    v_mfma_f32_16x16x32_bf16 v[192:195], v[68:71], v[36:39], v[192:195]
    ds_read_b64_tr_b16 v[84:85], v18 offset:28672
    v_mfma_f32_16x16x32_bf16 v[208:211], v[76:79], v[36:39], v[208:211]
    ds_read_b64_tr_b16 v[86:87], v18 offset:29184
    v_mfma_f32_16x16x32_bf16 v[196:199], v[64:67], v[40:43], v[196:199]
    ds_read_b64_tr_b16 v[88:89], v19 offset:24576
    v_cvt_pk_bf16_f32 v104, v168, v169
    v_mfma_f32_16x16x32_bf16 v[212:215], v[72:75], v[40:43], v[212:215]
    ds_read_b64_tr_b16 v[90:91], v19 offset:25088
    v_cvt_pk_bf16_f32 v105, v170, v171
    v_mfma_f32_16x16x32_bf16 v[196:199], v[68:71], v[44:47], v[196:199]
    ds_read_b64_tr_b16 v[92:93], v19 offset:28672
    v_cvt_pk_bf16_f32 v106, v172, v173
    v_mfma_f32_16x16x32_bf16 v[212:215], v[76:79], v[44:47], v[212:215]
    ds_read_b64_tr_b16 v[94:95], v19 offset:29184
    v_cvt_pk_bf16_f32 v107, v174, v175
    v_mfma_f32_16x16x32_bf16 v[200:203], v[64:67], v[48:51], v[200:203]
    v_cvt_pk_bf16_f32 v108, v184, v185
    v_cvt_pk_bf16_f32 v109, v186, v187
    v_mfma_f32_16x16x32_bf16 v[216:219], v[72:75], v[48:51], v[216:219]
    v_cvt_pk_bf16_f32 v110, v188, v189
    v_cvt_pk_bf16_f32 v111, v190, v191
    v_mfma_f32_16x16x32_bf16 v[200:203], v[68:71], v[52:55], v[200:203]
    v_permlane16_swap_b32 v104, v106
    v_mfma_f32_16x16x32_bf16 v[216:219], v[76:79], v[52:55], v[216:219]
    v_permlane16_swap_b32 v105, v107
    v_mfma_f32_16x16x32_bf16 v[204:207], v[64:67], v[56:59], v[204:207]
    v_permlane16_swap_b32 v108, v110
    v_mfma_f32_16x16x32_bf16 v[220:223], v[72:75], v[56:59], v[220:223]
    v_permlane16_swap_b32 v109, v111
    v_mfma_f32_16x16x32_bf16 v[204:207], v[68:71], v[60:63], v[204:207]
    s_waitcnt lgkmcnt(0)
    ds_write_b128 v7, v[104:107] offset:2048
    v_mfma_f32_16x16x32_bf16 v[220:223], v[76:79], v[60:63], v[220:223]
    ds_write_b128 v7, v[108:111] offset:3072
    v_mfma_f32_16x16x32_bf16 v[224:227], v[32:35], v[80:83], v[224:227]
    v_cvt_pk_bf16_f32 v16, v160, v161
    v_cvt_pk_bf16_f32 v17, v162, v163
    v_mfma_f32_16x16x32_bf16 v[240:243], v[32:35], v[88:91], v[240:243]
    v_cvt_pk_bf16_f32 v18, v164, v165
    v_cvt_pk_bf16_f32 v19, v166, v167
    v_mfma_f32_16x16x32_bf16 v[224:227], v[36:39], v[84:87], v[224:227]
    v_cvt_pk_bf16_f32 v20, v176, v177
    v_cvt_pk_bf16_f32 v21, v178, v179
    v_mfma_f32_16x16x32_bf16 v[240:243], v[36:39], v[92:95], v[240:243]
    v_cvt_pk_bf16_f32 v22, v180, v181
    v_cvt_pk_bf16_f32 v23, v182, v183
    v_mfma_f32_16x16x32_bf16 v[228:231], v[40:43], v[80:83], v[228:231]
    v_permlane16_swap_b32 v16, v18
    v_mfma_f32_16x16x32_bf16 v[244:247], v[40:43], v[88:91], v[244:247]
    v_permlane16_swap_b32 v17, v19
    v_mfma_f32_16x16x32_bf16 v[228:231], v[44:47], v[84:87], v[228:231]
    v_permlane16_swap_b32 v20, v22
    v_mfma_f32_16x16x32_bf16 v[244:247], v[44:47], v[92:95], v[244:247]
    v_permlane16_swap_b32 v21, v23
    v_mfma_f32_16x16x32_bf16 v[232:235], v[48:51], v[80:83], v[232:235]
    v_pk_mul_f32 v[192:193], v[192:193], s[62:63]
    v_pk_mul_f32 v[194:195], v[194:195], s[62:63]
    v_mfma_f32_16x16x32_bf16 v[248:251], v[48:51], v[88:91], v[248:251]
    v_cvt_pk_bf16_f32 v64, v192, v193
    v_cvt_pk_bf16_f32 v65, v194, v195
    v_mfma_f32_16x16x32_bf16 v[232:235], v[52:55], v[84:87], v[232:235]
    v_pk_mul_f32 v[196:197], v[196:197], s[62:63]
    v_pk_mul_f32 v[198:199], v[198:199], s[62:63]
    v_mfma_f32_16x16x32_bf16 v[248:251], v[52:55], v[92:95], v[248:251]
    v_cvt_pk_bf16_f32 v66, v196, v197
    v_cvt_pk_bf16_f32 v67, v198, v199
    v_mfma_f32_16x16x32_bf16 v[236:239], v[56:59], v[80:83], v[236:239]
    v_pk_mul_f32 v[208:209], v[208:209], s[62:63]
    v_pk_mul_f32 v[210:211], v[210:211], s[62:63]
    v_mfma_f32_16x16x32_bf16 v[252:255], v[56:59], v[88:91], v[252:255]
    v_cvt_pk_bf16_f32 v68, v208, v209
    v_cvt_pk_bf16_f32 v69, v210, v211
    v_mfma_f32_16x16x32_bf16 v[236:239], v[60:63], v[84:87], v[236:239]
    v_pk_mul_f32 v[212:213], v[212:213], s[62:63]
    v_pk_mul_f32 v[214:215], v[214:215], s[62:63]
    v_mfma_f32_16x16x32_bf16 v[252:255], v[60:63], v[92:95], v[252:255]
    s_waitcnt lgkmcnt(0)
    s_barrier
    v_cvt_pk_bf16_f32 v70, v212, v213
    v_cvt_pk_bf16_f32 v71, v214, v215
    v_permlane16_swap_b32 v64, v66
    v_permlane16_swap_b32 v65, v67
    v_permlane16_swap_b32 v68, v70
    v_permlane16_swap_b32 v69, v71
    buffer_store_dwordx4 v[64:67], v4, s[28:31], s92 offen sc1
    buffer_store_dwordx4 v[68:71], v4, s[28:31], s92 offen offset:1024 sc1
    v_pk_mul_f32 v[200:201], v[200:201], s[62:63]
    v_pk_mul_f32 v[202:203], v[202:203], s[62:63]
    v_cvt_pk_bf16_f32 v72, v200, v201
    v_cvt_pk_bf16_f32 v73, v202, v203
    v_pk_mul_f32 v[204:205], v[204:205], s[62:63]
    v_pk_mul_f32 v[206:207], v[206:207], s[62:63]
    v_cvt_pk_bf16_f32 v74, v204, v205
    v_cvt_pk_bf16_f32 v75, v206, v207
    v_pk_mul_f32 v[216:217], v[216:217], s[62:63]
    v_pk_mul_f32 v[218:219], v[218:219], s[62:63]
    v_cvt_pk_bf16_f32 v76, v216, v217
    v_cvt_pk_bf16_f32 v77, v218, v219
    v_pk_mul_f32 v[220:221], v[220:221], s[62:63]
    v_pk_mul_f32 v[222:223], v[222:223], s[62:63]
    v_cvt_pk_bf16_f32 v78, v220, v221
    v_cvt_pk_bf16_f32 v79, v222, v223
    v_permlane16_swap_b32 v72, v74
    v_permlane16_swap_b32 v73, v75
    v_permlane16_swap_b32 v76, v78
    v_permlane16_swap_b32 v77, v79
    buffer_store_dwordx4 v[72:75], v4, s[28:31], s93 offen sc1
    buffer_store_dwordx4 v[76:79], v4, s[28:31], s93 offen offset:1024 sc1
    v_cvt_pk_bf16_f32 v128, v224, v225
    v_cvt_pk_bf16_f32 v129, v226, v227
    v_cvt_pk_bf16_f32 v130, v240, v241
    v_cvt_pk_bf16_f32 v131, v242, v243
    v_cvt_pk_bf16_f32 v132, v228, v229
    v_cvt_pk_bf16_f32 v133, v230, v231
    v_cvt_pk_bf16_f32 v134, v244, v245
    v_cvt_pk_bf16_f32 v135, v246, v247
    v_permlane16_swap_b32 v128, v130
    v_permlane16_swap_b32 v129, v131
    v_permlane16_swap_b32 v132, v134
    v_permlane16_swap_b32 v133, v135
    buffer_store_dwordx4 v[128:131], v1, s[28:31], s96 offen offset:2048 sc1
    buffer_store_dwordx4 v[132:135], v1, s[28:31], s96 offen offset:3072 sc1
    v_cvt_pk_bf16_f32 v136, v232, v233
    v_cvt_pk_bf16_f32 v137, v234, v235
    v_cvt_pk_bf16_f32 v138, v248, v249
    v_cvt_pk_bf16_f32 v139, v250, v251
    v_cvt_pk_bf16_f32 v140, v236, v237
    v_cvt_pk_bf16_f32 v141, v238, v239
    v_cvt_pk_bf16_f32 v142, v252, v253
    v_cvt_pk_bf16_f32 v143, v254, v255
    v_permlane16_swap_b32 v136, v138
    v_permlane16_swap_b32 v137, v139
    v_permlane16_swap_b32 v140, v142
    v_permlane16_swap_b32 v141, v143
    buffer_store_dwordx4 v[136:139], v1, s[28:31], s97 offen offset:2048 sc1
    buffer_store_dwordx4 v[140:143], v1, s[28:31], s97 offen offset:3072 sc1
    s_branch f_attn
f_sig1:
    s_mov_b64 exec, 1
    v_mov_b32 v7, s64
    v_mov_b32 v190, 0
    s_lshl_b32 s56, s48, 4
    s_add_u32 s56, s56, s49
    s_lshl_b32 s56, s56, 4
    s_add_u32 s56, s56, 4202496
    buffer_store_dword v7, v190, s[28:31], s56 offen sc1
    s_mov_b64 exec, -1
    s_branch f_sig1_r
f_sig2:
    s_mov_b64 exec, 1
    v_mov_b32 v7, s64
    v_mov_b32 v190, 0
    s_lshl_b32 s56, s48, 4
    s_add_u32 s56, s56, s49
    s_lshl_b32 s56, s56, 4
    s_add_u32 s56, s56, 4206592
    buffer_store_dword v7, v190, s[28:31], s56 offen sc1
    s_mov_b64 exec, -1
    s_branch f_sig2_r
f_pre1:
    v_lshrrev_b32 v190, 4, v0
    v_min_u32 v190, 2, v190
    v_sub_u32 v190, s48, v190
    v_max_i32 v190, 0, v190
    v_lshlrev_b32 v190, 4, v190
    v_and_or_b32 v190, v0, 15, v190
    v_lshlrev_b32 v190, 4, v190
    s_mov_b32 s62, 4202496
    buffer_load_dword v7, v190, s[28:31], s62 offen sc1
    s_branch f_pre1_r
f_poll1:
    s_waitcnt vmcnt(0)
    s_mov_b32 s57, 50000
    s_branch f_pc1
f_pl1:
    s_mov_b32 s62, 4202496
    buffer_load_dword v7, v190, s[28:31], s62 offen sc1
    s_waitcnt vmcnt(0)
f_pc1:
    v_cmp_eq_u32 vcc, s64, v7
    s_cmp_eq_u64 vcc, -1
    s_cbranch_scc1 f_pd1
    s_sleep 12
    s_sub_u32 s57, s57, 1
    s_cmp_lg_u32 s57, 0
    s_cbranch_scc1 f_pl1
f_pd1:
    s_branch f_poll1_r
f_pre2:
    v_and_b32 v190, 15, v0
    v_lshlrev_b32 v190, 4, v190
    s_lshl_b32 s56, s54, 8
    v_add_u32 v190, s56, v190
    s_mov_b32 s62, 4206592
    buffer_load_dword v7, v190, s[28:31], s62 offen sc1
    s_branch f_pre2_r
f_poll2:
    s_waitcnt vmcnt(0)
    s_mov_b32 s57, 50000
    s_branch f_pc2
f_pl2:
    s_mov_b32 s62, 4206592
    buffer_load_dword v7, v190, s[28:31], s62 offen sc1
    s_waitcnt vmcnt(0)
f_pc2:
    v_cmp_eq_u32 vcc, s64, v7
    s_cmp_eq_u64 vcc, -1
    s_cbranch_scc1 f_pd2
    s_sleep 12
    s_sub_u32 s57, s57, 1
    s_cmp_lg_u32 s57, 0
    s_cbranch_scc1 f_pl2
f_pd2:
    s_branch f_poll2_r
f_cm2:
    v_mov_b32 v164, 0
    v_mov_b32 v165, 0
    v_mov_b32 v166, 0
    v_mov_b32 v167, 0
    v_mov_b32 v168, 0
    v_mov_b32 v169, 0
    v_mov_b32 v170, 0
    v_mov_b32 v171, 0
    v_mov_b32 v172, 0
    v_mov_b32 v173, 0
    v_mov_b32 v174, 0
    v_mov_b32 v175, 0
    v_mov_b32 v176, 0
    v_mov_b32 v177, 0
    v_mov_b32 v178, 0
    v_mov_b32 v179, 0
    s_nop 0
    s_branch f_cm2_r
f_cm3:
    v_mov_b32 v164, 0
    v_mov_b32 v165, 0
    v_mov_b32 v166, 0
    v_mov_b32 v167, 0
    v_mov_b32 v168, 0
    v_mov_b32 v169, 0
    v_mov_b32 v170, 0
    v_mov_b32 v171, 0
    v_mov_b32 v172, 0
    v_mov_b32 v173, 0
    v_mov_b32 v174, 0
    v_mov_b32 v175, 0
    v_mov_b32 v176, 0
    v_mov_b32 v177, 0
    v_mov_b32 v178, 0
    v_mov_b32 v179, 0
    s_nop 0
    s_branch f_cm3_r
f_cm4:
    v_mov_b32 v164, 0
    v_mov_b32 v165, 0
    v_mov_b32 v166, 0
    v_mov_b32 v167, 0
    v_mov_b32 v168, 0
    v_mov_b32 v169, 0
    v_mov_b32 v170, 0
    v_mov_b32 v171, 0
    v_mov_b32 v172, 0
    v_mov_b32 v173, 0
    v_mov_b32 v174, 0
    v_mov_b32 v175, 0
    v_mov_b32 v176, 0
    v_mov_b32 v177, 0
    v_mov_b32 v178, 0
    v_mov_b32 v179, 0
    s_nop 0
    s_branch f_cm4_r
f_cm5:
    v_mov_b32 v164, 0
    v_mov_b32 v165, 0
    v_mov_b32 v166, 0
    v_mov_b32 v167, 0
    v_mov_b32 v168, 0
    v_mov_b32 v169, 0
    v_mov_b32 v170, 0
    v_mov_b32 v171, 0
    v_mov_b32 v172, 0
    v_mov_b32 v173, 0
    v_mov_b32 v174, 0
    v_mov_b32 v175, 0
    v_mov_b32 v176, 0
    v_mov_b32 v177, 0
    v_mov_b32 v178, 0
    v_mov_b32 v179, 0
    s_nop 0
    s_branch f_cm5_r
f_cm6:
    v_mov_b32 v164, 0
    v_mov_b32 v165, 0
    v_mov_b32 v166, 0
    v_mov_b32 v167, 0
    v_mov_b32 v168, 0
    v_mov_b32 v169, 0
    v_mov_b32 v170, 0
    v_mov_b32 v171, 0
    v_mov_b32 v172, 0
    v_mov_b32 v173, 0
    v_mov_b32 v174, 0
    v_mov_b32 v175, 0
    v_mov_b32 v176, 0
    v_mov_b32 v177, 0
    v_mov_b32 v178, 0
    v_mov_b32 v179, 0
    s_nop 0
    s_branch f_cm6_r
f_cm7:
    v_mov_b32 v164, 0
    v_mov_b32 v165, 0
    v_mov_b32 v166, 0
    v_mov_b32 v167, 0
    v_mov_b32 v168, 0
    v_mov_b32 v169, 0
    v_mov_b32 v170, 0
    v_mov_b32 v171, 0
    v_mov_b32 v172, 0
    v_mov_b32 v173, 0
    v_mov_b32 v174, 0
    v_mov_b32 v175, 0
    v_mov_b32 v176, 0
    v_mov_b32 v177, 0
    v_mov_b32 v178, 0
    v_mov_b32 v179, 0
    s_nop 0
    s_branch f_cm7_r
f_slowB:
    s_waitcnt vmcnt(0) lgkmcnt(0)
    s_lshl_b32 s101, s65, 18
    s_add_u32 s101, s101, 8388608
    s_sub_i32 s97, s52, 8
    s_max_i32 s98, s97, 0
    s_mov_b32 s95, s52
    s_mov_b32 s96, s52
    v_mov_b32 v128, 0
    v_mov_b32 v129, 0
    v_mov_b32 v130, 0
    v_mov_b32 v131, 0
    v_mov_b32 v132, 0
    v_mov_b32 v133, 0
    v_mov_b32 v134, 0
    v_mov_b32 v135, 0
    v_mov_b32 v136, 0
    v_mov_b32 v137, 0
    v_mov_b32 v138, 0
    v_mov_b32 v139, 0
    v_mov_b32 v140, 0
    v_mov_b32 v141, 0
    v_mov_b32 v142, 0
    v_mov_b32 v143, 0
    v_mov_b32 v144, 0
    v_mov_b32 v145, 0
    v_mov_b32 v146, 0
    v_mov_b32 v147, 0
    v_mov_b32 v148, 4048155338
    s_mov_b32 s99, 0
f_spassB:
    s_mov_b32 s100, s98
f_stileB:
    s_lshl_b32 s56, s100, 12
    s_add_u32 s56, s56, s101
    buffer_load_dwordx4 v[196:199], v1, s[28:31], s56 offen sc1
    buffer_load_dwordx4 v[200:203], v1, s[28:31], s56 offen offset:1024 sc1
    buffer_load_dwordx4 v[204:207], v1, s[28:31], s56 offen offset:2048 sc1
    buffer_load_dwordx4 v[208:211], v1, s[28:31], s56 offen offset:3072 sc1
    s_cmp_eq_u32 s100, s96
    s_cselect_b32 s56, 4048155338, 0
    s_cmp_eq_u32 s100, s97
    s_cselect_b32 s57, 4048155338, 0
    v_mov_b32 v150, s56
    v_mov_b32 v151, s57
    v_cmp_le_i32 vcc, 0, v6
    s_nop 1
    v_cndmask_b32 v228, v150, v151, vcc
    v_cmp_le_i32 vcc, 1, v6
    s_nop 1
    v_cndmask_b32 v229, v150, v151, vcc
    v_cmp_le_i32 vcc, 2, v6
    s_nop 1
    v_cndmask_b32 v230, v150, v151, vcc
    v_cmp_le_i32 vcc, 3, v6
    s_nop 1
    v_cndmask_b32 v231, v150, v151, vcc
    v_cmp_le_i32 vcc, 4, v6
    s_nop 1
    v_cndmask_b32 v232, v150, v151, vcc
    v_cmp_le_i32 vcc, 5, v6
    s_nop 1
    v_cndmask_b32 v233, v150, v151, vcc
    v_cmp_le_i32 vcc, 6, v6
    s_nop 1
    v_cndmask_b32 v234, v150, v151, vcc
    v_cmp_le_i32 vcc, 7, v6
    s_nop 1
    v_cndmask_b32 v235, v150, v151, vcc
    v_cmp_le_i32 vcc, 16, v6
    s_nop 1
    v_cndmask_b32 v236, v150, v151, vcc
    v_cmp_le_i32 vcc, 17, v6
    s_nop 1
    v_cndmask_b32 v237, v150, v151, vcc
    v_cmp_le_i32 vcc, 18, v6
    s_nop 1
    v_cndmask_b32 v238, v150, v151, vcc
    v_cmp_le_i32 vcc, 19, v6
    s_nop 1
    v_cndmask_b32 v239, v150, v151, vcc
    v_cmp_le_i32 vcc, 20, v6
    s_nop 1
    v_cndmask_b32 v240, v150, v151, vcc
    v_cmp_le_i32 vcc, 21, v6
    s_nop 1
    v_cndmask_b32 v241, v150, v151, vcc
    v_cmp_le_i32 vcc, 22, v6
    s_nop 1
    v_cndmask_b32 v242, v150, v151, vcc
    v_cmp_le_i32 vcc, 23, v6
    s_nop 1
    v_cndmask_b32 v243, v150, v151, vcc
    s_waitcnt vmcnt(0)
    s_nop 0
    v_mfma_f32_32x32x16_bf16 v[212:227], v[196:199], v[16:19], v[228:243]
    v_mfma_f32_32x32x16_bf16 v[212:227], v[200:203], v[20:23], v[212:227]
    s_nop 7
    s_nop 7
    s_cmp_eq_u32 s99, 0
    s_cbranch_scc0 f_sp2B
    v_max_f32 v148, v148, v212
    v_max_f32 v148, v148, v213
    v_max_f32 v148, v148, v214
    v_max_f32 v148, v148, v215
    v_max_f32 v148, v148, v216
    v_max_f32 v148, v148, v217
    v_max_f32 v148, v148, v218
    v_max_f32 v148, v148, v219
    v_max_f32 v148, v148, v220
    v_max_f32 v148, v148, v221
    v_max_f32 v148, v148, v222
    v_max_f32 v148, v148, v223
    v_max_f32 v148, v148, v224
    v_max_f32 v148, v148, v225
    v_max_f32 v148, v148, v226
    v_max_f32 v148, v148, v227
    s_branch f_snextB
f_sp2B:
    v_sub_f32 v212, v212, v148
    v_sub_f32 v213, v213, v148
    v_sub_f32 v214, v214, v148
    v_sub_f32 v215, v215, v148
    v_sub_f32 v216, v216, v148
    v_sub_f32 v217, v217, v148
    v_sub_f32 v218, v218, v148
    v_sub_f32 v219, v219, v148
    v_sub_f32 v220, v220, v148
    v_sub_f32 v221, v221, v148
    v_sub_f32 v222, v222, v148
    v_sub_f32 v223, v223, v148
    v_sub_f32 v224, v224, v148
    v_sub_f32 v225, v225, v148
    v_sub_f32 v226, v226, v148
    v_sub_f32 v227, v227, v148
    v_exp_f32 v212, v212
    v_exp_f32 v213, v213
    v_exp_f32 v214, v214
    v_exp_f32 v215, v215
    v_exp_f32 v216, v216
    v_exp_f32 v217, v217
    v_exp_f32 v218, v218
    v_exp_f32 v219, v219
    v_exp_f32 v220, v220
    v_exp_f32 v221, v221
    v_exp_f32 v222, v222
    v_exp_f32 v223, v223
    v_exp_f32 v224, v224
    v_exp_f32 v225, v225
    v_exp_f32 v226, v226
    v_exp_f32 v227, v227
    s_nop 0
    v_cvt_pk_bf16_f32 v244, v212, v213
    v_cvt_pk_bf16_f32 v245, v214, v215
    v_cvt_pk_bf16_f32 v246, v216, v217
    v_cvt_pk_bf16_f32 v247, v218, v219
    v_cvt_pk_bf16_f32 v248, v220, v221
    v_cvt_pk_bf16_f32 v249, v222, v223
    v_cvt_pk_bf16_f32 v250, v224, v225
    v_cvt_pk_bf16_f32 v251, v226, v227
    s_nop 1
    v_mfma_f32_32x32x16_bf16 v[128:143], v[204:207], v[244:247], v[128:143]
    v_mfma_f32_32x32x16_bf16 v[128:143], v[208:211], v[248:251], v[128:143]
    v_smfmac_f32_16x16x64_bf16 v[144:147], v[8:11], v[244:251], v5
    s_nop 7
    s_nop 7
f_snextB:
    s_add_u32 s100, s100, 1
    s_cmp_le_u32 s100, s95
    s_cbranch_scc1 f_stileB
    s_cmp_eq_u32 s99, 0
    s_cbranch_scc0 f_sdoneB
    v_mov_b32 v149, v148
    s_nop 1
    v_permlane32_swap_b32 v148, v149
    s_nop 1
    v_max_f32 v148, v148, v149
    s_mov_b32 s99, 1
    s_branch f_spassB
f_sdoneB:
    s_mov_b32 s63, 1
    s_branch f_normB
f_slowA:
    s_waitcnt vmcnt(0) lgkmcnt(0)
    s_mov_b32 s101, 16777216
    s_mov_b32 s98, 0
    s_mov_b32 s95, 63
    s_mov_b32 s96, -1
    s_mov_b32 s97, -1
    v_mov_b32 v96, 0
    v_mov_b32 v97, 0
    v_mov_b32 v98, 0
    v_mov_b32 v99, 0
    v_mov_b32 v100, 0
    v_mov_b32 v101, 0
    v_mov_b32 v102, 0
    v_mov_b32 v103, 0
    v_mov_b32 v104, 0
    v_mov_b32 v105, 0
    v_mov_b32 v106, 0
    v_mov_b32 v107, 0
    v_mov_b32 v108, 0
    v_mov_b32 v109, 0
    v_mov_b32 v110, 0
    v_mov_b32 v111, 0
    v_mov_b32 v12, 0
    v_mov_b32 v13, 0
    v_mov_b32 v14, 0
    v_mov_b32 v15, 0
    v_mov_b32 v120, 4048155338
    s_mov_b32 s99, 0
f_spassA:
    s_mov_b32 s100, s98
f_stileA:
    s_lshl_b32 s56, s100, 12
    s_add_u32 s56, s56, s101
    buffer_load_dwordx4 v[32:35], v1, s[28:31], s56 offen sc1
    buffer_load_dwordx4 v[36:39], v1, s[28:31], s56 offen offset:1024 sc1
    buffer_load_dwordx4 v[40:43], v1, s[28:31], s56 offen offset:2048 sc1
    buffer_load_dwordx4 v[44:47], v1, s[28:31], s56 offen offset:3072 sc1
    s_cmp_eq_u32 s100, s96
    s_cselect_b32 s56, 4048155338, 0
    s_cmp_eq_u32 s100, s97
    s_cselect_b32 s57, 4048155338, 0
    v_mov_b32 v122, s56
    v_mov_b32 v123, s57
    v_cmp_le_i32 vcc, 0, v6
    s_nop 1
    v_cndmask_b32 v80, v122, v123, vcc
    v_cmp_le_i32 vcc, 1, v6
    s_nop 1
    v_cndmask_b32 v81, v122, v123, vcc
    v_cmp_le_i32 vcc, 2, v6
    s_nop 1
    v_cndmask_b32 v82, v122, v123, vcc
    v_cmp_le_i32 vcc, 3, v6
    s_nop 1
    v_cndmask_b32 v83, v122, v123, vcc
    v_cmp_le_i32 vcc, 4, v6
    s_nop 1
    v_cndmask_b32 v84, v122, v123, vcc
    v_cmp_le_i32 vcc, 5, v6
    s_nop 1
    v_cndmask_b32 v85, v122, v123, vcc
    v_cmp_le_i32 vcc, 6, v6
    s_nop 1
    v_cndmask_b32 v86, v122, v123, vcc
    v_cmp_le_i32 vcc, 7, v6
    s_nop 1
    v_cndmask_b32 v87, v122, v123, vcc
    v_cmp_le_i32 vcc, 16, v6
    s_nop 1
    v_cndmask_b32 v88, v122, v123, vcc
    v_cmp_le_i32 vcc, 17, v6
    s_nop 1
    v_cndmask_b32 v89, v122, v123, vcc
    v_cmp_le_i32 vcc, 18, v6
    s_nop 1
    v_cndmask_b32 v90, v122, v123, vcc
    v_cmp_le_i32 vcc, 19, v6
    s_nop 1
    v_cndmask_b32 v91, v122, v123, vcc
    v_cmp_le_i32 vcc, 20, v6
    s_nop 1
    v_cndmask_b32 v92, v122, v123, vcc
    v_cmp_le_i32 vcc, 21, v6
    s_nop 1
    v_cndmask_b32 v93, v122, v123, vcc
    v_cmp_le_i32 vcc, 22, v6
    s_nop 1
    v_cndmask_b32 v94, v122, v123, vcc
    v_cmp_le_i32 vcc, 23, v6
    s_nop 1
    v_cndmask_b32 v95, v122, v123, vcc
    s_waitcnt vmcnt(0)
    s_nop 0
    v_mfma_f32_32x32x16_bf16 v[64:79], v[32:35], v[24:27], v[80:95]
    v_mfma_f32_32x32x16_bf16 v[64:79], v[36:39], v[28:31], v[64:79]
    s_nop 7
    s_nop 7
    s_cmp_eq_u32 s99, 0
    s_cbranch_scc0 f_sp2A
    v_max_f32 v120, v120, v64
    v_max_f32 v120, v120, v65
    v_max_f32 v120, v120, v66
    v_max_f32 v120, v120, v67
    v_max_f32 v120, v120, v68
    v_max_f32 v120, v120, v69
    v_max_f32 v120, v120, v70
    v_max_f32 v120, v120, v71
    v_max_f32 v120, v120, v72
    v_max_f32 v120, v120, v73
    v_max_f32 v120, v120, v74
    v_max_f32 v120, v120, v75
    v_max_f32 v120, v120, v76
    v_max_f32 v120, v120, v77
    v_max_f32 v120, v120, v78
    v_max_f32 v120, v120, v79
    s_branch f_snextA
f_sp2A:
    v_sub_f32 v64, v64, v120
    v_sub_f32 v65, v65, v120
    v_sub_f32 v66, v66, v120
    v_sub_f32 v67, v67, v120
    v_sub_f32 v68, v68, v120
    v_sub_f32 v69, v69, v120
    v_sub_f32 v70, v70, v120
    v_sub_f32 v71, v71, v120
    v_sub_f32 v72, v72, v120
    v_sub_f32 v73, v73, v120
    v_sub_f32 v74, v74, v120
    v_sub_f32 v75, v75, v120
    v_sub_f32 v76, v76, v120
    v_sub_f32 v77, v77, v120
    v_sub_f32 v78, v78, v120
    v_sub_f32 v79, v79, v120
    v_exp_f32 v64, v64
    v_exp_f32 v65, v65
    v_exp_f32 v66, v66
    v_exp_f32 v67, v67
    v_exp_f32 v68, v68
    v_exp_f32 v69, v69
    v_exp_f32 v70, v70
    v_exp_f32 v71, v71
    v_exp_f32 v72, v72
    v_exp_f32 v73, v73
    v_exp_f32 v74, v74
    v_exp_f32 v75, v75
    v_exp_f32 v76, v76
    v_exp_f32 v77, v77
    v_exp_f32 v78, v78
    v_exp_f32 v79, v79
    s_nop 0
    v_cvt_pk_bf16_f32 v48, v64, v65
    v_cvt_pk_bf16_f32 v49, v66, v67
    v_cvt_pk_bf16_f32 v50, v68, v69
    v_cvt_pk_bf16_f32 v51, v70, v71
    v_cvt_pk_bf16_f32 v52, v72, v73
    v_cvt_pk_bf16_f32 v53, v74, v75
    v_cvt_pk_bf16_f32 v54, v76, v77
    v_cvt_pk_bf16_f32 v55, v78, v79
    s_nop 1
    v_mfma_f32_32x32x16_bf16 v[96:111], v[40:43], v[48:51], v[96:111]
    v_mfma_f32_32x32x16_bf16 v[96:111], v[44:47], v[52:55], v[96:111]
    v_smfmac_f32_16x16x64_bf16 v[12:15], v[8:11], v[48:55], v5
    s_nop 7
    s_nop 7
f_snextA:
    s_add_u32 s100, s100, 1
    s_cmp_le_u32 s100, s95
    s_cbranch_scc1 f_stileA
    s_cmp_eq_u32 s99, 0
    s_cbranch_scc0 f_sdoneA
    v_mov_b32 v121, v120
    s_nop 1
    v_permlane32_swap_b32 v120, v121
    s_nop 1
    v_max_f32 v120, v120, v121
    s_mov_b32 s99, 1
    s_branch f_spassA
f_sdoneA:
    s_mov_b32 s63, 1
    s_branch f_normA
.p2align 4
f_last:
    s_endpgm
.section .rodata,"a"
.p2align 6
.amdhsa_kernel gated_mix__grouped_kv_mqa__sliding_block__prompt_kernel
  .amdhsa_next_free_vgpr 256
  .amdhsa_next_free_sgpr 102
  .amdhsa_accum_offset 256
  .amdhsa_group_segment_fixed_size 0
  .amdhsa_kernarg_size 96
  .amdhsa_user_sgpr_count 2
  .amdhsa_user_sgpr_kernarg_segment_ptr 1
  .amdhsa_system_sgpr_workgroup_id_x 1
.end_amdhsa_kernel
```
